```python
import torch

def _softmax(x, axis=-1):
    return torch.softmax(x, dim=axis)
def _gelu(x):
    return torch.nn.functional.gelu(x, approximate="tanh")
def _silu(x):
    return torch.nn.functional.silu(x)
def _sigmoid(x):
    return torch.sigmoid(x)
def _layernorm(x, axis=-1, eps=1e-5):
    m = x.mean(dim=axis, keepdim=True)
    v = x.var(dim=axis, keepdim=True, unbiased=False)
    return (x - m) / torch.sqrt(v + eps)
def _scatter_add(tgt, idx, src, axis=0):
    return tgt.clone().index_add_(axis, idx, src)
def _segment_sum(src, seg, n):
    out = torch.zeros((n,) + src.shape[1:], dtype=src.dtype)
    return out.index_add_(0, seg, src)
def _pad(x, pw):
    flat = tuple(v for pair in reversed(pw) for v in pair)
    return torch.nn.functional.pad(x, flat)

kernel_name = 'sequential_preLN__ssm_conv_h3__glu_gated_swiglu__prompt'

def setup_inputs():

    _w = (lambda a: (lambda t: t.to(torch.bfloat16) if t.is_floating_point() else t)(torch.as_tensor(a)))
    def _A_setup():
        B, S, D = 1, 2048, 640
        ks = 4
        return {
            "q": _w((lambda *s: torch.randn(*s, dtype=torch.bfloat16) * 0.05)(B, S, D)),
            "k": _w((lambda *s: torch.randn(*s, dtype=torch.bfloat16) * 0.2)(B, S, D)),
            "v": _w((lambda *s: torch.randn(*s, dtype=torch.bfloat16) * 0.2)(B, S, D)),
            "shift_k": _w((lambda *s: torch.randn(*s, dtype=torch.bfloat16) * 0.2)(D, ks) * 0.5),
            "ssm_k": _w((lambda *s: torch.randn(*s, dtype=torch.bfloat16) * 0.4)(D, S) * (1.0 / S ** 0.5)),
            "ssm_D": _w((lambda *s: torch.randn(*s, dtype=torch.bfloat16) * 0.2)(D)),
        }
    _A_in = _A_setup()

    def _B_setup():
        B, S, D, F = 1, 2048, 640, 1728
        return {
            "x": _w((lambda *s: torch.randn(*s, dtype=torch.bfloat16) * 0.05)(B, S, D)),
            "w1": _w((lambda *s: torch.randn(*s, dtype=torch.bfloat16) * 0.2)(D, F) * (2.0 / D) ** 0.5),
            "w3": _w((lambda *s: torch.randn(*s, dtype=torch.bfloat16) * 0.2)(D, F) * (2.0 / D) ** 0.5),
            "w2": _w((lambda *s: torch.randn(*s, dtype=torch.bfloat16) * 0.2)(F, D) * (2.0 / F) ** 0.5),
        }
    _B_in = _B_setup()

    return {
        "A_q": _A_in["q"],
        "A_k": _A_in["k"],
        "A_v": _A_in["v"],
        "A_shift_k": _A_in["shift_k"],
        "A_ssm_k": _A_in["ssm_k"],
        "A_ssm_D": _A_in["ssm_D"],
        "B_x": _B_in["x"],
        "B_w1": _B_in["w1"],
        "B_w3": _B_in["w3"],
        "B_w2": _B_in["w2"],
    }

def reference(A_q, A_k, A_v, A_shift_k, A_ssm_k, A_ssm_D, B_x, B_w1, B_w3, B_w2):
    def _A_ref(q, k, v, shift_k, ssm_k, ssm_D):
        B, S, D = q.shape
        ks = shift_k.shape[-1]
        k_pad = _pad(k, ((0, 0), (ks - 1, 0), (0, 0)))
        k_shift = torch.zeros_like(k)
        for t in range(ks):
            k_shift = k_shift + k_pad[:, t:t + S, :] * shift_k[:, ks - 1 - t][None, None, :]
        kv = k_shift * v
        L = 2 * S
        kv_pad = _pad(kv, ((0, 0), (0, S), (0, 0)))
        kf_pad = _pad(ssm_k, ((0, 0), (0, S)))
        kv_f = (lambda x, axes=(-2,-1): torch.fft.rfft2(x.float(), dim=axes))(kv_pad[:, None, :, :], axes=(1, 2))
        kf_f = (lambda x, axes=(-2,-1): torch.fft.rfft2(x.float(), dim=axes))(kf_pad[:, None, :], axes=(1, 2))
        kf_f = (lambda x, *d: x.permute(*d))(kf_f, 1, 2, 0)
        y_f = kv_f * kf_f[None, :, :, :]
        y = (lambda x, s, axes=(-2,-1): torch.fft.irfft2(x, s=s, dim=axes).to(torch.bfloat16))(y_f, (1, L), axes=(1, 2))[:, 0, :S, :]
        y = y + kv * ssm_D[None, None, :]
        return q * y

    def _B_ref(x, w1, w3, w2):
        gate = torch.einsum("bsd,df->bsf", x, w1)
        up = torch.einsum("bsd,df->bsf", x, w3)
        h = _silu(gate) * up
        out = torch.einsum("bsf,fd->bsd", h, w2)
        return out

    x = A_q
    h = x + _A_ref(_layernorm(x, axis=-1), A_k, A_v, A_shift_k, A_ssm_k, A_ssm_D)
    h2 = h + _B_ref(_layernorm(h, axis=-1), B_w1, B_w3, B_w2)
    return h2
```

```asm
; @launch kernel=front_kernel grid=(256,1,1) block=(384,1,1) lds=87552
; @launch kernel=back_kernel grid=(256,1,1) block=(256,1,1) lds=163840
.amdgcn_target "amdgcn-amd-amdhsa--gfx950"
.text
.globl front_kernel
.p2align 8
.type front_kernel,@function
front_kernel:
    s_cmp_ge_u32 s2, 256
    s_cbranch_scc1 k0_end
    s_load_dwordx4 s[4:7], s[0:1], 0
    s_load_dwordx4 s[8:11], s[0:1], 16
    s_load_dwordx2 s[12:13], s[0:1], 96
    s_load_dwordx4 s[40:43], s[0:1], 32
    s_getpc_b64 s[68:69]
k0_pc0:
    s_mov_b32 s70, code_end-k0_pc0
    s_mov_b32 s71, 0x20000
    v_lshlrev_b32 v1, 7, v0
    buffer_load_dword v92, v1, s[68:71], 0 offen
    v_lshrrev_b32 v1, 6, v0
    s_and_b32 s3, s2, 7
    s_lshl_b32 s3, s3, 5
    v_readfirstlane_b32 s81, v1
    s_lshr_b32 s14, s2, 3
    s_add_u32 s3, s3, s14
    s_mul_i32 s14, s3, 10240
    s_waitcnt lgkmcnt(0)
    s_mov_b32 s16, s4
    s_mov_b32 s17, s5
    s_mov_b32 s18, 0x280000
    s_mov_b32 s19, 0x20000
    s_cmp_eq_u32 s81, 5
    s_cbranch_scc1 k0_stats
    s_mov_b32 s20, s6
    s_mov_b32 s21, s7
    s_mov_b32 s22, 0x280000
    s_mov_b32 s23, 0x20000
    s_mov_b32 s24, s8
    s_mov_b32 s25, s9
    s_mov_b32 s26, 0x280000
    s_mov_b32 s27, 0x20000
    s_mov_b32 s28, s10
    s_mov_b32 s29, s11
    s_mov_b32 s30, 0x1400
    s_mov_b32 s31, 0x20000
    s_mov_b32 s32, s12
    s_mov_b32 s33, s13
    s_mov_b32 s34, 0x505000
    s_mov_b32 s35, 0x20000
    v_lshl_add_u32 v2, v0, 2, s14
    v_lshlrev_b32 v5, 4, v0
    v_add_u32 v3, 0xfffff100, v2
    v_add_u32 v4, 5120, v2
    buffer_load_dwordx4 v[36:39], v5, s[28:31], 0 offen
    buffer_load_dword v8, v3, s[20:23], 0 offen offset:0
    buffer_load_dword v9, v3, s[20:23], 0 offen offset:1280
    buffer_load_dword v10, v3, s[20:23], 0 offen offset:2560
    buffer_load_dword v11, v2, s[20:23], 0 offen offset:0
    buffer_load_dword v12, v2, s[20:23], 0 offen offset:1280
    buffer_load_dword v13, v2, s[20:23], 0 offen offset:2560
    buffer_load_dword v14, v2, s[20:23], 0 offen offset:3840
    buffer_load_dword v15, v4, s[20:23], 0 offen offset:0
    buffer_load_dword v16, v4, s[20:23], 0 offen offset:1280
    buffer_load_dword v17, v4, s[20:23], 0 offen offset:2560
    buffer_load_dword v18, v4, s[20:23], 0 offen offset:3840
    buffer_load_dword v19, v2, s[24:27], 0 offen offset:0
    buffer_load_dword v20, v2, s[24:27], 0 offen offset:1280
    buffer_load_dword v21, v2, s[24:27], 0 offen offset:2560
    buffer_load_dword v22, v2, s[24:27], 0 offen offset:3840
    buffer_load_dword v23, v4, s[24:27], 0 offen offset:0
    buffer_load_dword v24, v4, s[24:27], 0 offen offset:1280
    buffer_load_dword v25, v4, s[24:27], 0 offen offset:2560
    buffer_load_dword v26, v4, s[24:27], 0 offen offset:3840
    buffer_load_dword v27, v2, s[16:19], 0 offen offset:0
    buffer_load_dword v28, v2, s[16:19], 0 offen offset:1280
    buffer_load_dword v29, v2, s[16:19], 0 offen offset:2560
    buffer_load_dword v30, v2, s[16:19], 0 offen offset:3840
    buffer_load_dword v31, v4, s[16:19], 0 offen offset:0
    buffer_load_dword v32, v4, s[16:19], 0 offen offset:1280
    buffer_load_dword v33, v4, s[16:19], 0 offen offset:2560
    buffer_load_dword v34, v4, s[16:19], 0 offen offset:3840
    s_mov_b32 s44, s40
    s_mov_b32 s45, s41
    s_mov_b32 s46, 0x280000
    s_mov_b32 s47, 0x20000
    s_mov_b32 s48, s42
    s_mov_b32 s49, s43
    s_mov_b32 s50, 0x500
    s_mov_b32 s51, 0x20000
    s_and_b32 s64, s2, 7
    s_mul_i32 s64, s64, 20
    s_lshr_b32 s15, s2, 3
    s_add_u32 s64, s64, s15
    s_lshl_b32 s39, s64, 2
    s_add_u32 s39, s39, s81
    s_cmp_ge_u32 s2, 160
    s_cselect_b32 s39, 0x40000, s39
    s_cmp_eq_u32 s81, 4
    s_cselect_b32 s39, 0x40000, s39
    s_lshl_b32 s66, s39, 12
    s_lshl_b32 s39, s39, 1
    s_mul_i32 s40, s81, 8448
    s_add_u32 s40, s40, 37376
    v_and_b32 v1, 63, v0
    v_lshlrev_b32 v94, 4, v1
    v_add_u32 v95, s40, v94
    s_lshr_b32 s15, s3, 1
    s_and_b32 s15, s15, 7
    s_lshl_b32 s15, s15, 4
    v_lshrrev_b32 v6, 1, v0
    v_and_b32 v7, 1, v0
    v_lshlrev_b32 v6, 7, v6
    v_lshl_or_b32 v6, v7, 5, v6
    v_xor_b32 v6, s15, v6
    v_xor_b32 v7, 16, v6
    v_xor_b32 v88, 64, v6
    v_xor_b32 v89, 0x50, v6
    v_and_b32 v1, 63, v0
    s_lshl_b32 s15, s81, 12
    v_lshl_add_u32 v90, v1, 4, s15
    v_lshrrev_b32 v91, 3, v1
    s_lshl_b32 s15, s81, 5
    v_add_u32 v91, s15, v91
    v_mul_u32_u24 v91, 32896, v91
    v_and_b32 v1, 7, v1
    s_lshl_b32 s15, s3, 7
    v_lshl_add_u32 v1, v1, 4, s15
    v_add_u32 v91, v91, v1
    s_mov_b32 s36, 0xffff0000
    s_mov_b32 s37, 0x05040100
    s_mov_b32 s38, 0x07060302
    s_waitcnt vmcnt(27)
    v_lshlrev_b32 v40, 16, v36
    v_lshlrev_b32 v41, 16, v38
    v_and_b32 v42, s36, v36
    v_and_b32 v43, s36, v38
    v_lshlrev_b32 v44, 16, v37
    v_lshlrev_b32 v45, 16, v39
    v_and_b32 v46, s36, v37
    v_and_b32 v47, s36, v39
    s_waitcnt vmcnt(16) lgkmcnt(0)
    v_lshlrev_b32 v48, 16, v8
    v_and_b32 v49, s36, v8
    v_lshlrev_b32 v50, 16, v9
    v_and_b32 v51, s36, v9
    v_lshlrev_b32 v52, 16, v10
    v_and_b32 v53, s36, v10
    v_lshlrev_b32 v54, 16, v11
    v_and_b32 v55, s36, v11
    v_lshlrev_b32 v56, 16, v12
    v_and_b32 v57, s36, v12
    v_lshlrev_b32 v58, 16, v13
    v_and_b32 v59, s36, v13
    v_lshlrev_b32 v60, 16, v14
    v_and_b32 v61, s36, v14
    v_lshlrev_b32 v62, 16, v15
    v_and_b32 v63, s36, v15
    v_lshlrev_b32 v64, 16, v16
    v_and_b32 v65, s36, v16
    v_lshlrev_b32 v66, 16, v17
    v_and_b32 v67, s36, v17
    v_lshlrev_b32 v68, 16, v18
    v_and_b32 v69, s36, v18
    v_pk_mul_f32 v[72:73], v[54:55], v[40:41]
    v_pk_mul_f32 v[74:75], v[56:57], v[40:41]
    v_pk_mul_f32 v[76:77], v[58:59], v[40:41]
    v_pk_mul_f32 v[78:79], v[60:61], v[40:41]
    v_pk_mul_f32 v[80:81], v[62:63], v[40:41]
    v_pk_mul_f32 v[82:83], v[64:65], v[40:41]
    v_pk_mul_f32 v[84:85], v[66:67], v[40:41]
    v_pk_mul_f32 v[86:87], v[68:69], v[40:41]
    v_pk_fma_f32 v[72:73], v[52:53], v[42:43], v[72:73]
    v_pk_fma_f32 v[74:75], v[54:55], v[42:43], v[74:75]
    v_pk_fma_f32 v[76:77], v[56:57], v[42:43], v[76:77]
    v_pk_fma_f32 v[78:79], v[58:59], v[42:43], v[78:79]
    v_pk_fma_f32 v[80:81], v[60:61], v[42:43], v[80:81]
    v_pk_fma_f32 v[82:83], v[62:63], v[42:43], v[82:83]
    v_pk_fma_f32 v[84:85], v[64:65], v[42:43], v[84:85]
    v_pk_fma_f32 v[86:87], v[66:67], v[42:43], v[86:87]
    v_pk_fma_f32 v[72:73], v[50:51], v[44:45], v[72:73]
    v_pk_fma_f32 v[74:75], v[52:53], v[44:45], v[74:75]
    v_pk_fma_f32 v[76:77], v[54:55], v[44:45], v[76:77]
    v_pk_fma_f32 v[78:79], v[56:57], v[44:45], v[78:79]
    v_pk_fma_f32 v[80:81], v[58:59], v[44:45], v[80:81]
    v_pk_fma_f32 v[82:83], v[60:61], v[44:45], v[82:83]
    v_pk_fma_f32 v[84:85], v[62:63], v[44:45], v[84:85]
    v_pk_fma_f32 v[86:87], v[64:65], v[44:45], v[86:87]
    v_pk_fma_f32 v[72:73], v[48:49], v[46:47], v[72:73]
    v_pk_fma_f32 v[74:75], v[50:51], v[46:47], v[74:75]
    v_pk_fma_f32 v[76:77], v[52:53], v[46:47], v[76:77]
    v_pk_fma_f32 v[78:79], v[54:55], v[46:47], v[78:79]
    v_pk_fma_f32 v[80:81], v[56:57], v[46:47], v[80:81]
    v_pk_fma_f32 v[82:83], v[58:59], v[46:47], v[82:83]
    v_pk_fma_f32 v[84:85], v[60:61], v[46:47], v[84:85]
    v_pk_fma_f32 v[86:87], v[62:63], v[46:47], v[86:87]
    s_waitcnt vmcnt(8)
    v_lshlrev_b32 v48, 16, v19
    v_and_b32 v49, s36, v19
    v_lshlrev_b32 v50, 16, v20
    v_and_b32 v51, s36, v20
    v_lshlrev_b32 v52, 16, v21
    v_and_b32 v53, s36, v21
    v_lshlrev_b32 v54, 16, v22
    v_and_b32 v55, s36, v22
    v_lshlrev_b32 v56, 16, v23
    v_and_b32 v57, s36, v23
    v_lshlrev_b32 v58, 16, v24
    v_and_b32 v59, s36, v24
    v_lshlrev_b32 v60, 16, v25
    v_and_b32 v61, s36, v25
    v_lshlrev_b32 v62, 16, v26
    v_and_b32 v63, s36, v26
    v_pk_mul_f32 v[72:73], v[72:73], v[48:49]
    v_pk_mul_f32 v[74:75], v[74:75], v[50:51]
    v_pk_mul_f32 v[76:77], v[76:77], v[52:53]
    v_pk_mul_f32 v[78:79], v[78:79], v[54:55]
    v_pk_mul_f32 v[80:81], v[80:81], v[56:57]
    v_pk_mul_f32 v[82:83], v[82:83], v[58:59]
    v_pk_mul_f32 v[84:85], v[84:85], v[60:61]
    v_pk_mul_f32 v[86:87], v[86:87], v[62:63]
    v_cvt_pk_bf16_f32 v8, v86, v84
    v_cvt_pk_bf16_f32 v9, v82, v80
    v_cvt_pk_bf16_f32 v10, v78, v76
    v_cvt_pk_bf16_f32 v11, v74, v72
    v_cvt_pk_bf16_f32 v12, v87, v85
    v_cvt_pk_bf16_f32 v13, v83, v81
    v_cvt_pk_bf16_f32 v14, v79, v77
    v_cvt_pk_bf16_f32 v15, v75, v73
    ds_write_b128 v6, v[8:11] offset:4608
    ds_write_b128 v7, v[12:15] offset:4608
    s_waitcnt vmcnt(0)
    v_perm_b32 v48, v28, v27, s37
    v_perm_b32 v49, v30, v29, s37
    v_perm_b32 v50, v32, v31, s37
    v_perm_b32 v51, v34, v33, s37
    v_perm_b32 v52, v28, v27, s38
    v_perm_b32 v53, v30, v29, s38
    v_perm_b32 v54, v32, v31, s38
    v_perm_b32 v55, v34, v33, s38
    ds_write_b128 v88, v[48:51] offset:4608
    ds_write_b128 v89, v[52:55] offset:4608
    ds_read_b128 v[72:75], v90 offset:4608
    ds_read_b128 v[76:79], v90 offset:5632
    ds_read_b128 v[80:83], v90 offset:6656
    ds_read_b128 v[84:87], v90 offset:7680
    s_mov_b32 s15, 0
    s_waitcnt lgkmcnt(3)
    buffer_store_dwordx4 v[72:75], v91, s[32:35], s15 offen sc1
    s_mov_b32 s15, 263168
    s_waitcnt lgkmcnt(2)
    buffer_store_dwordx4 v[76:79], v91, s[32:35], s15 offen sc1
    s_mov_b32 s15, 526336
    s_waitcnt lgkmcnt(1)
    buffer_store_dwordx4 v[80:83], v91, s[32:35], s15 offen sc1
    s_mov_b32 s15, 789504
    s_waitcnt lgkmcnt(0)
    buffer_store_dwordx4 v[84:87], v91, s[32:35], s15 offen sc1
    s_cmp_lt_u32 s39, 0x40000
    s_cbranch_scc1 k1_conv
    s_cmp_eq_u32 s81, 4
    s_waitcnt vmcnt(0)
    s_barrier
    s_cbranch_scc0 k1_aux0
    s_bfm_b64 exec, 32, 0
    s_endpgm
k1_conv:
    s_mov_b32 s3, s64
    v_and_b32 v1, 63, v0
    v_mov_b32 v2, v94
    v_mov_b32 v16, 0
    v_mov_b32 v17, 0
    v_mov_b32 v18, 0
    v_mov_b32 v19, 0
    v_mov_b32 v20, 0
    v_mov_b32 v21, 0
    v_mov_b32 v22, 0
    v_mov_b32 v23, 0
    v_mov_b32 v24, 0
    v_mov_b32 v25, 0
    v_mov_b32 v26, 0
    v_mov_b32 v27, 0
    v_mov_b32 v28, 0
    v_mov_b32 v29, 0
    v_mov_b32 v30, 0
    v_mov_b32 v31, 0
    v_mov_b32 v32, 0
    v_mov_b32 v33, 0
    v_mov_b32 v34, 0
    v_mov_b32 v35, 0
    v_mov_b32 v36, 0
    v_mov_b32 v37, 0
    v_mov_b32 v38, 0
    v_mov_b32 v39, 0
    v_mov_b32 v40, 0
    v_mov_b32 v41, 0
    v_mov_b32 v42, 0
    v_mov_b32 v43, 0
    v_mov_b32 v44, 0
    v_mov_b32 v45, 0
    v_mov_b32 v46, 0
    v_mov_b32 v47, 0
    v_lshlrev_b32 v6, 4, v0
    ds_write_b128 v6, v[16:19] offset:512
    v_and_b32 v6, 1, v1
    v_lshl_add_u32 v6, v6, 4, s40
    ds_write_b128 v6, v[16:19]
    ds_write_b128 v6, v[16:19] offset:4160
    v_and_b32 v14, 15, v1
    v_lshrrev_b32 v15, 4, v1
    v_and_b32 v6, 1, v1
    v_xor_b32 v6, 1, v6
    v_mul_u32_u24 v6, 4162, v6
    v_lshl_add_u32 v7, v15, 3, v14
    v_lshl_add_u32 v6, v7, 1, v6
    v_add3_u32 v8, v6, s40, 2
    v_add_u32 v9, 1024, v8
    v_add_u32 v10, 2048, v8
    v_add_u32 v11, 3072, v8
    v_lshlrev_b32 v13, 1, v14
    v_sub_u32 v13, v13, v15
    v_add_u32 v13, 33, v13
    v_mov_b32 v6, s40
    v_bfe_u32 v12, v13, 1, 3
    v_xor_b32 v12, s81, v12
    v_lshlrev_b32 v12, 4, v12
    v_lshl_add_u32 v12, v13, 7, v12
    v_add_u32 v13, -4, v13
    s_waitcnt vmcnt(0)
    s_barrier
    s_mov_b32 s20, s12
    s_mov_b32 s21, s13
    s_mov_b32 s22, 0x505000
    s_mov_b32 s23, 0x20000
    s_add_u32 s28, s12, 0x50fc00
    s_addc_u32 s29, s13, 0
    s_mov_b32 s30, 0x4400
    s_mov_b32 s31, 0x20000
    s_add_u32 s32, s12, 0x520000
    s_addc_u32 s33, s13, 0
    s_mov_b32 s34, 0x28a000
    s_mov_b32 s35, 0x20000
    s_lshl_b32 s42, s81, 13
    s_add_u32 s41, s42, 4608
    s_mul_i32 s43, s3, 32896
    s_add_u32 s43, s43, s42
    s_lshl_b32 s42, s81, 12
    s_add_u32 m0, s40, 32
    s_nop 0
    buffer_load_dwordx4 v94, s[44:47], s66 offen offset:0 lds
    buffer_load_dwordx4 v94, s[44:47], s66 offen offset:1024 lds
    buffer_load_dwordx4 v94, s[44:47], s66 offen offset:2048 lds
    buffer_load_dwordx4 v94, s[44:47], s66 offen offset:3072 lds
    buffer_load_ushort v93, off, s[48:51], s39
    s_mov_b32 m0, s41
    s_barrier
    buffer_load_dwordx4 v2, s[20:23], s43 offen offset:0 sc1 lds
    buffer_load_dwordx4 v2, s[20:23], s43 offen offset:1024 sc1 lds
    buffer_load_dwordx4 v2, s[20:23], s43 offen offset:2048 sc1 lds
    buffer_load_dwordx4 v2, s[20:23], s43 offen offset:3072 sc1 lds
    s_add_u32 m0, s41, 4096
    s_add_u32 s43, s43, 4096
    buffer_load_dwordx4 v2, s[20:23], s43 offen offset:0 sc1 lds
    buffer_load_dwordx4 v2, s[20:23], s43 offen offset:1024 sc1 lds
    buffer_load_dwordx4 v2, s[20:23], s43 offen offset:2048 sc1 lds
    buffer_load_dwordx4 v2, s[20:23], s43 offen offset:3072 sc1 lds
    v_and_b32 v7, 15, v1
    v_lshlrev_b32 v7, 7, v7
    v_and_or_b32 v7, v1, 16, v7
    v_and_b32 v3, 32, v1
    v_lshl_or_b32 v3, v3, 1, v7
    s_add_u32 m0, s42, 71168
    s_add_u32 s41, s42, 32
    s_add_u32 s42, s42, 1024
    buffer_load_dwordx4 v3, s[28:31], s42 offen offset:0 sc1 lds
    buffer_load_dwordx4 v3, s[28:31], s41 offen offset:1024 sc1 lds
    buffer_load_dwordx4 v3, s[28:31], s42 offen offset:2048 sc1 lds
    buffer_load_dwordx4 v3, s[28:31], s41 offen offset:3072 sc1 lds
    s_waitcnt vmcnt(12)
    ds_read_b32 v51, v95 offset:28
    ds_read_b128 v[52:55], v95 offset:32
    ds_read_b32 v59, v95 offset:1052
    ds_read_b128 v[60:63], v95 offset:1056
    ds_read_b32 v67, v95 offset:2076
    ds_read_b128 v[68:71], v95 offset:2080
    ds_read_b32 v75, v95 offset:3100
    ds_read_b128 v[76:79], v95 offset:3104
    v_lshlrev_b32 v4, 16, v93
    s_waitcnt lgkmcnt(6)
    v_alignbit_b32 v48, v52, v51, 16
    v_alignbit_b32 v49, v53, v52, 16
    v_alignbit_b32 v50, v54, v53, 16
    v_alignbit_b32 v51, v55, v54, 16
    ds_write_b128 v95, v[48:51] offset:4192
    s_waitcnt lgkmcnt(5)
    v_alignbit_b32 v56, v60, v59, 16
    v_alignbit_b32 v57, v61, v60, 16
    v_alignbit_b32 v58, v62, v61, 16
    v_alignbit_b32 v59, v63, v62, 16
    ds_write_b128 v95, v[56:59] offset:5216
    s_waitcnt lgkmcnt(4)
    v_alignbit_b32 v64, v68, v67, 16
    v_alignbit_b32 v65, v69, v68, 16
    v_alignbit_b32 v66, v70, v69, 16
    v_alignbit_b32 v67, v71, v70, 16
    ds_write_b128 v95, v[64:67] offset:6240
    s_waitcnt lgkmcnt(3)
    v_alignbit_b32 v72, v76, v75, 16
    v_alignbit_b32 v73, v77, v76, 16
    v_alignbit_b32 v74, v78, v77, 16
    v_alignbit_b32 v75, v79, v78, 16
    ds_write_b128 v95, v[72:75] offset:7264
    s_waitcnt vmcnt(4) lgkmcnt(0)
    s_barrier
    ds_read_b128 v[80:83], v12 offset:512
    ds_read2_b32 v[48:49], v8 offset0:0 offset1:1
    ds_read2_b32 v[50:51], v8 offset0:2 offset1:3
    ds_read_b128 v[84:87], v12 offset:4608
    ds_read2_b32 v[52:53], v8 offset0:128 offset1:129
    ds_read2_b32 v[54:55], v8 offset0:130 offset1:131
    ds_read_b128 v[88:91], v12 offset:8704
    ds_read2_b32 v[56:57], v9 offset0:0 offset1:1
    ds_read2_b32 v[58:59], v9 offset0:2 offset1:3
    ds_read_b128 v[92:95], v12 offset:12800
    ds_read2_b32 v[60:61], v9 offset0:128 offset1:129
    ds_read2_b32 v[62:63], v9 offset0:130 offset1:131
    ds_read_b128 v[96:99], v12 offset:16896
    ds_read2_b32 v[64:65], v10 offset0:0 offset1:1
    ds_read2_b32 v[66:67], v10 offset0:2 offset1:3
    ds_read_b128 v[100:103], v12 offset:20992
    ds_read2_b32 v[68:69], v10 offset0:128 offset1:129
    ds_read2_b32 v[70:71], v10 offset0:130 offset1:131
    ds_read_b128 v[104:107], v12 offset:25088
    ds_read2_b32 v[72:73], v11 offset0:0 offset1:1
    ds_read2_b32 v[74:75], v11 offset0:2 offset1:3
    ds_read_b128 v[108:111], v12 offset:29184
    ds_read2_b32 v[76:77], v11 offset0:128 offset1:129
    ds_read2_b32 v[78:79], v11 offset0:130 offset1:131
    v_add_u32 v8, 64, v8
    v_add_u32 v9, 64, v9
    v_add_u32 v10, 64, v10
    v_add_u32 v11, 64, v11
    v_bfe_u32 v12, v13, 1, 3
    v_xor_b32 v12, s81, v12
    v_lshlrev_b32 v12, 4, v12
    v_lshl_add_u32 v12, v13, 7, v12
    v_add_u32 v13, -4, v13
    s_mov_b32 s44, 4
k1_loop:
    s_waitcnt lgkmcnt(0)
    v_mfma_f32_16x16x32_bf16 v[16:19], v[48:51], v[80:83], v[16:19]
    ds_read_b128 v[144:147], v12 offset:512
    v_mfma_f32_16x16x32_bf16 v[44:47], v[76:79], v[80:83], v[44:47]
    ds_read2_b32 v[112:113], v8 offset0:0 offset1:1
    v_mfma_f32_16x16x32_bf16 v[20:23], v[48:51], v[84:87], v[20:23]
    ds_read2_b32 v[114:115], v8 offset0:2 offset1:3
    v_mfma_f32_16x16x32_bf16 v[24:27], v[48:51], v[88:91], v[24:27]
    ds_read_b128 v[148:151], v12 offset:4608
    v_mfma_f32_16x16x32_bf16 v[28:31], v[48:51], v[92:95], v[28:31]
    ds_read2_b32 v[116:117], v8 offset0:128 offset1:129
    v_mfma_f32_16x16x32_bf16 v[32:35], v[48:51], v[96:99], v[32:35]
    ds_read2_b32 v[118:119], v8 offset0:130 offset1:131
    v_mfma_f32_16x16x32_bf16 v[36:39], v[48:51], v[100:103], v[36:39]
    ds_read_b128 v[152:155], v12 offset:8704
    v_mfma_f32_16x16x32_bf16 v[40:43], v[48:51], v[104:107], v[40:43]
    ds_read2_b32 v[120:121], v9 offset0:0 offset1:1
    v_mfma_f32_16x16x32_bf16 v[44:47], v[48:51], v[108:111], v[44:47]
    ds_read2_b32 v[122:123], v9 offset0:2 offset1:3
    v_mfma_f32_16x16x32_bf16 v[20:23], v[52:55], v[80:83], v[20:23]
    ds_read_b128 v[156:159], v12 offset:12800
    v_mfma_f32_16x16x32_bf16 v[24:27], v[52:55], v[84:87], v[24:27]
    ds_read2_b32 v[124:125], v9 offset0:128 offset1:129
    v_mfma_f32_16x16x32_bf16 v[28:31], v[52:55], v[88:91], v[28:31]
    ds_read2_b32 v[126:127], v9 offset0:130 offset1:131
    v_mfma_f32_16x16x32_bf16 v[32:35], v[52:55], v[92:95], v[32:35]
    ds_read_b128 v[160:163], v12 offset:16896
    v_mfma_f32_16x16x32_bf16 v[36:39], v[52:55], v[96:99], v[36:39]
    ds_read2_b32 v[128:129], v10 offset0:0 offset1:1
    v_mfma_f32_16x16x32_bf16 v[40:43], v[52:55], v[100:103], v[40:43]
    ds_read2_b32 v[130:131], v10 offset0:2 offset1:3
    v_mfma_f32_16x16x32_bf16 v[44:47], v[52:55], v[104:107], v[44:47]
    ds_read_b128 v[164:167], v12 offset:20992
    v_mfma_f32_16x16x32_bf16 v[24:27], v[56:59], v[80:83], v[24:27]
    ds_read2_b32 v[132:133], v10 offset0:128 offset1:129
    v_mfma_f32_16x16x32_bf16 v[28:31], v[56:59], v[84:87], v[28:31]
    ds_read2_b32 v[134:135], v10 offset0:130 offset1:131
    v_mfma_f32_16x16x32_bf16 v[32:35], v[56:59], v[88:91], v[32:35]
    ds_read_b128 v[168:171], v12 offset:25088
    v_mfma_f32_16x16x32_bf16 v[36:39], v[56:59], v[92:95], v[36:39]
    ds_read2_b32 v[136:137], v11 offset0:0 offset1:1
    v_mfma_f32_16x16x32_bf16 v[40:43], v[56:59], v[96:99], v[40:43]
    ds_read2_b32 v[138:139], v11 offset0:2 offset1:3
    v_mfma_f32_16x16x32_bf16 v[44:47], v[56:59], v[100:103], v[44:47]
    ds_read_b128 v[172:175], v12 offset:29184
    v_mfma_f32_16x16x32_bf16 v[28:31], v[60:63], v[80:83], v[28:31]
    ds_read2_b32 v[140:141], v11 offset0:128 offset1:129
    v_mfma_f32_16x16x32_bf16 v[32:35], v[60:63], v[84:87], v[32:35]
    ds_read2_b32 v[142:143], v11 offset0:130 offset1:131
    v_mfma_f32_16x16x32_bf16 v[36:39], v[60:63], v[88:91], v[36:39]
    v_add_u32 v8, 64, v8
    v_mfma_f32_16x16x32_bf16 v[40:43], v[60:63], v[92:95], v[40:43]
    v_add_u32 v9, 64, v9
    v_mfma_f32_16x16x32_bf16 v[44:47], v[60:63], v[96:99], v[44:47]
    v_add_u32 v10, 64, v10
    v_mfma_f32_16x16x32_bf16 v[32:35], v[64:67], v[80:83], v[32:35]
    v_add_u32 v11, 64, v11
    v_mfma_f32_16x16x32_bf16 v[36:39], v[64:67], v[84:87], v[36:39]
    v_bfe_u32 v12, v13, 1, 3
    v_mfma_f32_16x16x32_bf16 v[40:43], v[64:67], v[88:91], v[40:43]
    v_xor_b32 v12, s81, v12
    v_mfma_f32_16x16x32_bf16 v[44:47], v[64:67], v[92:95], v[44:47]
    v_lshlrev_b32 v12, 4, v12
    v_mfma_f32_16x16x32_bf16 v[36:39], v[68:71], v[80:83], v[36:39]
    v_lshl_add_u32 v12, v13, 7, v12
    v_mfma_f32_16x16x32_bf16 v[40:43], v[68:71], v[84:87], v[40:43]
    v_add_u32 v13, -4, v13
    v_mfma_f32_16x16x32_bf16 v[44:47], v[68:71], v[88:91], v[44:47]
    v_mfma_f32_16x16x32_bf16 v[40:43], v[72:75], v[80:83], v[40:43]
    v_mfma_f32_16x16x32_bf16 v[44:47], v[72:75], v[84:87], v[44:47]
    s_waitcnt lgkmcnt(0)
    v_mfma_f32_16x16x32_bf16 v[16:19], v[112:115], v[144:147], v[16:19]
    ds_read_b128 v[80:83], v12 offset:512
    v_mfma_f32_16x16x32_bf16 v[44:47], v[140:143], v[144:147], v[44:47]
    ds_read2_b32 v[48:49], v8 offset0:0 offset1:1
    v_mfma_f32_16x16x32_bf16 v[20:23], v[112:115], v[148:151], v[20:23]
    ds_read2_b32 v[50:51], v8 offset0:2 offset1:3
    v_mfma_f32_16x16x32_bf16 v[24:27], v[112:115], v[152:155], v[24:27]
    ds_read_b128 v[84:87], v12 offset:4608
    v_mfma_f32_16x16x32_bf16 v[28:31], v[112:115], v[156:159], v[28:31]
    ds_read2_b32 v[52:53], v8 offset0:128 offset1:129
    v_mfma_f32_16x16x32_bf16 v[32:35], v[112:115], v[160:163], v[32:35]
    ds_read2_b32 v[54:55], v8 offset0:130 offset1:131
    v_mfma_f32_16x16x32_bf16 v[36:39], v[112:115], v[164:167], v[36:39]
    ds_read_b128 v[88:91], v12 offset:8704
    v_mfma_f32_16x16x32_bf16 v[40:43], v[112:115], v[168:171], v[40:43]
    ds_read2_b32 v[56:57], v9 offset0:0 offset1:1
    v_mfma_f32_16x16x32_bf16 v[44:47], v[112:115], v[172:175], v[44:47]
    ds_read2_b32 v[58:59], v9 offset0:2 offset1:3
    v_mfma_f32_16x16x32_bf16 v[20:23], v[116:119], v[144:147], v[20:23]
    ds_read_b128 v[92:95], v12 offset:12800
    v_mfma_f32_16x16x32_bf16 v[24:27], v[116:119], v[148:151], v[24:27]
    ds_read2_b32 v[60:61], v9 offset0:128 offset1:129
    v_mfma_f32_16x16x32_bf16 v[28:31], v[116:119], v[152:155], v[28:31]
    ds_read2_b32 v[62:63], v9 offset0:130 offset1:131
    v_mfma_f32_16x16x32_bf16 v[32:35], v[116:119], v[156:159], v[32:35]
    ds_read_b128 v[96:99], v12 offset:16896
    v_mfma_f32_16x16x32_bf16 v[36:39], v[116:119], v[160:163], v[36:39]
    ds_read2_b32 v[64:65], v10 offset0:0 offset1:1
    v_mfma_f32_16x16x32_bf16 v[40:43], v[116:119], v[164:167], v[40:43]
    ds_read2_b32 v[66:67], v10 offset0:2 offset1:3
    v_mfma_f32_16x16x32_bf16 v[44:47], v[116:119], v[168:171], v[44:47]
    ds_read_b128 v[100:103], v12 offset:20992
    v_mfma_f32_16x16x32_bf16 v[24:27], v[120:123], v[144:147], v[24:27]
    ds_read2_b32 v[68:69], v10 offset0:128 offset1:129
    v_mfma_f32_16x16x32_bf16 v[28:31], v[120:123], v[148:151], v[28:31]
    ds_read2_b32 v[70:71], v10 offset0:130 offset1:131
    v_mfma_f32_16x16x32_bf16 v[32:35], v[120:123], v[152:155], v[32:35]
    ds_read_b128 v[104:107], v12 offset:25088
    v_mfma_f32_16x16x32_bf16 v[36:39], v[120:123], v[156:159], v[36:39]
    ds_read2_b32 v[72:73], v11 offset0:0 offset1:1
    v_mfma_f32_16x16x32_bf16 v[40:43], v[120:123], v[160:163], v[40:43]
    ds_read2_b32 v[74:75], v11 offset0:2 offset1:3
    v_mfma_f32_16x16x32_bf16 v[44:47], v[120:123], v[164:167], v[44:47]
    ds_read_b128 v[108:111], v12 offset:29184
    v_mfma_f32_16x16x32_bf16 v[28:31], v[124:127], v[144:147], v[28:31]
    ds_read2_b32 v[76:77], v11 offset0:128 offset1:129
    v_mfma_f32_16x16x32_bf16 v[32:35], v[124:127], v[148:151], v[32:35]
    ds_read2_b32 v[78:79], v11 offset0:130 offset1:131
    v_mfma_f32_16x16x32_bf16 v[36:39], v[124:127], v[152:155], v[36:39]
    v_add_u32 v8, 64, v8
    v_mfma_f32_16x16x32_bf16 v[40:43], v[124:127], v[156:159], v[40:43]
    v_add_u32 v9, 64, v9
    v_mfma_f32_16x16x32_bf16 v[44:47], v[124:127], v[160:163], v[44:47]
    v_add_u32 v10, 64, v10
    v_mfma_f32_16x16x32_bf16 v[32:35], v[128:131], v[144:147], v[32:35]
    v_add_u32 v11, 64, v11
    v_mfma_f32_16x16x32_bf16 v[36:39], v[128:131], v[148:151], v[36:39]
    v_bfe_u32 v12, v13, 1, 3
    v_mfma_f32_16x16x32_bf16 v[40:43], v[128:131], v[152:155], v[40:43]
    v_xor_b32 v12, s81, v12
    v_mfma_f32_16x16x32_bf16 v[44:47], v[128:131], v[156:159], v[44:47]
    v_lshlrev_b32 v12, 4, v12
    v_mfma_f32_16x16x32_bf16 v[36:39], v[132:135], v[144:147], v[36:39]
    v_lshl_add_u32 v12, v13, 7, v12
    v_mfma_f32_16x16x32_bf16 v[40:43], v[132:135], v[148:151], v[40:43]
    v_add_u32 v13, -4, v13
    v_mfma_f32_16x16x32_bf16 v[44:47], v[132:135], v[152:155], v[44:47]
    v_mfma_f32_16x16x32_bf16 v[40:43], v[136:139], v[144:147], v[40:43]
    v_mfma_f32_16x16x32_bf16 v[44:47], v[136:139], v[148:151], v[44:47]
    s_add_u32 s44, s44, -1
    s_cmp_lg_u32 s44, 0
    s_cbranch_scc1 k1_loop
    v_lshrrev_b32 v6, 1, v15
    v_lshl_add_u32 v6, v14, 1, v6
    v_and_b32 v7, 7, v14
    v_xor_b32 v7, s81, v7
    v_lshlrev_b32 v7, 4, v7
    v_lshl_add_u32 v6, v6, 7, v7
    v_and_b32 v7, 1, v15
    v_lshl_or_b32 v6, v7, 3, v6
    v_xor_b32 v8, 8, v6
    v_xor_b32 v9, 64, v6
    v_lshlrev_b32 v10, 4, v15
    v_lshl_add_u32 v10, v14, 6, v10
    v_lshrrev_b32 v11, 1, v10
    v_add_u32 v10, 71168, v2
    s_lshl_b32 s41, s81, 6
    s_add_u32 s41, s41, s40
    v_add_u32 v11, s41, v11
    v_mov_b32 v5, v4
    s_mov_b32 s36, 0xffff0000
    s_waitcnt vmcnt(0) lgkmcnt(0)
    s_barrier
    ds_read_b64 v[48:49], v8 offset:4608
    ds_read_b64 v[50:51], v9 offset:4608
    ds_read_b128 v[52:55], v10 offset:0
    ds_read_b128 v[56:59], v10 offset:1024
    ds_read_b64 v[60:61], v8 offset:8704
    ds_read_b64 v[62:63], v9 offset:8704
    ds_read_b128 v[64:67], v10 offset:2048
    ds_read_b128 v[68:71], v10 offset:3072
    ds_read_b64 v[72:73], v8 offset:12800
    ds_read_b64 v[74:75], v9 offset:12800
    ds_read_b128 v[76:79], v10 offset:4096
    ds_read_b128 v[80:83], v10 offset:5120
    s_waitcnt lgkmcnt(8)
    ds_read_b64 v[84:85], v8 offset:16896
    ds_read_b64 v[86:87], v9 offset:16896
    ds_read_b128 v[88:91], v10 offset:6144
    ds_read_b128 v[92:95], v10 offset:7168
    v_and_b32 v160, s36, v49
    v_lshlrev_b32 v161, 16, v49
    v_and_b32 v162, s36, v48
    v_lshlrev_b32 v163, 16, v48
    v_lshlrev_b32 v164, 16, v50
    v_and_b32 v165, s36, v50
    v_lshlrev_b32 v166, 16, v51
    v_and_b32 v167, s36, v51
    v_pk_fma_f32 v[16:17], v[160:161], v[4:5], v[16:17]
    v_pk_fma_f32 v[18:19], v[162:163], v[4:5], v[18:19]
    v_pk_fma_f32 v[52:53], v[164:165], v[52:53], v[56:57]
    v_pk_fma_f32 v[54:55], v[166:167], v[54:55], v[58:59]
    v_pk_fma_f32 v[16:17], v[52:53], v[16:17], v[164:165]
    v_pk_fma_f32 v[18:19], v[54:55], v[18:19], v[166:167]
    v_cvt_pk_bf16_f32 v16, v16, v17
    v_cvt_pk_bf16_f32 v17, v18, v19
    ds_write_b64 v11, v[16:17] offset:0
    s_waitcnt lgkmcnt(9)
    ds_read_b64 v[96:97], v8 offset:20992
    ds_read_b64 v[98:99], v9 offset:20992
    ds_read_b128 v[100:103], v10 offset:8192
    ds_read_b128 v[104:107], v10 offset:9216
    v_and_b32 v160, s36, v61
    v_lshlrev_b32 v161, 16, v61
    v_and_b32 v162, s36, v60
    v_lshlrev_b32 v163, 16, v60
    v_lshlrev_b32 v164, 16, v62
    v_and_b32 v165, s36, v62
    v_lshlrev_b32 v166, 16, v63
    v_and_b32 v167, s36, v63
    v_pk_fma_f32 v[20:21], v[160:161], v[4:5], v[20:21]
    v_pk_fma_f32 v[22:23], v[162:163], v[4:5], v[22:23]
    v_pk_fma_f32 v[64:65], v[164:165], v[64:65], v[68:69]
    v_pk_fma_f32 v[66:67], v[166:167], v[66:67], v[70:71]
    v_pk_fma_f32 v[20:21], v[64:65], v[20:21], v[164:165]
    v_pk_fma_f32 v[22:23], v[66:67], v[22:23], v[166:167]
    v_cvt_pk_bf16_f32 v20, v20, v21
    v_cvt_pk_bf16_f32 v21, v22, v23
    ds_write_b64 v11, v[20:21] offset:512
    s_waitcnt lgkmcnt(10)
    ds_read_b64 v[108:109], v8 offset:25088
    ds_read_b64 v[110:111], v9 offset:25088
    ds_read_b128 v[112:115], v10 offset:10240
    ds_read_b128 v[116:119], v10 offset:11264
    v_and_b32 v160, s36, v73
    v_lshlrev_b32 v161, 16, v73
    v_and_b32 v162, s36, v72
    v_lshlrev_b32 v163, 16, v72
    v_lshlrev_b32 v164, 16, v74
    v_and_b32 v165, s36, v74
    v_lshlrev_b32 v166, 16, v75
    v_and_b32 v167, s36, v75
    v_pk_fma_f32 v[24:25], v[160:161], v[4:5], v[24:25]
    v_pk_fma_f32 v[26:27], v[162:163], v[4:5], v[26:27]
    v_pk_fma_f32 v[76:77], v[164:165], v[76:77], v[80:81]
    v_pk_fma_f32 v[78:79], v[166:167], v[78:79], v[82:83]
    v_pk_fma_f32 v[24:25], v[76:77], v[24:25], v[164:165]
    v_pk_fma_f32 v[26:27], v[78:79], v[26:27], v[166:167]
    v_cvt_pk_bf16_f32 v24, v24, v25
    v_cvt_pk_bf16_f32 v25, v26, v27
    ds_write_b64 v11, v[24:25] offset:1024
    s_waitcnt lgkmcnt(10)
    ds_read_b64 v[120:121], v8 offset:29184
    ds_read_b64 v[122:123], v9 offset:29184
    ds_read_b128 v[124:127], v10 offset:12288
    ds_read_b128 v[128:131], v10 offset:13312
    v_and_b32 v160, s36, v85
    v_lshlrev_b32 v161, 16, v85
    v_and_b32 v162, s36, v84
    v_lshlrev_b32 v163, 16, v84
    v_lshlrev_b32 v164, 16, v86
    v_and_b32 v165, s36, v86
    v_lshlrev_b32 v166, 16, v87
    v_and_b32 v167, s36, v87
    v_pk_fma_f32 v[28:29], v[160:161], v[4:5], v[28:29]
    v_pk_fma_f32 v[30:31], v[162:163], v[4:5], v[30:31]
    v_pk_fma_f32 v[88:89], v[164:165], v[88:89], v[92:93]
    v_pk_fma_f32 v[90:91], v[166:167], v[90:91], v[94:95]
    v_pk_fma_f32 v[28:29], v[88:89], v[28:29], v[164:165]
    v_pk_fma_f32 v[30:31], v[90:91], v[30:31], v[166:167]
    v_cvt_pk_bf16_f32 v28, v28, v29
    v_cvt_pk_bf16_f32 v29, v30, v31
    ds_write_b64 v11, v[28:29] offset:1536
    s_waitcnt lgkmcnt(10)
    ds_read_b64 v[132:133], v8 offset:33280
    ds_read_b64 v[134:135], v9 offset:33280
    ds_read_b128 v[136:139], v10 offset:14336
    ds_read_b128 v[140:143], v10 offset:15360
    v_and_b32 v160, s36, v97
    v_lshlrev_b32 v161, 16, v97
    v_and_b32 v162, s36, v96
    v_lshlrev_b32 v163, 16, v96
    v_lshlrev_b32 v164, 16, v98
    v_and_b32 v165, s36, v98
    v_lshlrev_b32 v166, 16, v99
    v_and_b32 v167, s36, v99
    v_pk_fma_f32 v[32:33], v[160:161], v[4:5], v[32:33]
    v_pk_fma_f32 v[34:35], v[162:163], v[4:5], v[34:35]
    v_pk_fma_f32 v[100:101], v[164:165], v[100:101], v[104:105]
    v_pk_fma_f32 v[102:103], v[166:167], v[102:103], v[106:107]
    v_pk_fma_f32 v[32:33], v[100:101], v[32:33], v[164:165]
    v_pk_fma_f32 v[34:35], v[102:103], v[34:35], v[166:167]
    v_cvt_pk_bf16_f32 v32, v32, v33
    v_cvt_pk_bf16_f32 v33, v34, v35
    ds_write_b64 v11, v[32:33] offset:2048
    s_waitcnt lgkmcnt(10)
    v_and_b32 v160, s36, v109
    v_lshlrev_b32 v161, 16, v109
    v_and_b32 v162, s36, v108
    v_lshlrev_b32 v163, 16, v108
    v_lshlrev_b32 v164, 16, v110
    v_and_b32 v165, s36, v110
    v_lshlrev_b32 v166, 16, v111
    v_and_b32 v167, s36, v111
    v_pk_fma_f32 v[36:37], v[160:161], v[4:5], v[36:37]
    v_pk_fma_f32 v[38:39], v[162:163], v[4:5], v[38:39]
    v_pk_fma_f32 v[112:113], v[164:165], v[112:113], v[116:117]
    v_pk_fma_f32 v[114:115], v[166:167], v[114:115], v[118:119]
    v_pk_fma_f32 v[36:37], v[112:113], v[36:37], v[164:165]
    v_pk_fma_f32 v[38:39], v[114:115], v[38:39], v[166:167]
    v_cvt_pk_bf16_f32 v36, v36, v37
    v_cvt_pk_bf16_f32 v37, v38, v39
    ds_write_b64 v11, v[36:37] offset:2560
    s_waitcnt lgkmcnt(6)
    v_and_b32 v160, s36, v121
    v_lshlrev_b32 v161, 16, v121
    v_and_b32 v162, s36, v120
    v_lshlrev_b32 v163, 16, v120
    v_lshlrev_b32 v164, 16, v122
    v_and_b32 v165, s36, v122
    v_lshlrev_b32 v166, 16, v123
    v_and_b32 v167, s36, v123
    v_pk_fma_f32 v[40:41], v[160:161], v[4:5], v[40:41]
    v_pk_fma_f32 v[42:43], v[162:163], v[4:5], v[42:43]
    v_pk_fma_f32 v[124:125], v[164:165], v[124:125], v[128:129]
    v_pk_fma_f32 v[126:127], v[166:167], v[126:127], v[130:131]
    v_pk_fma_f32 v[40:41], v[124:125], v[40:41], v[164:165]
    v_pk_fma_f32 v[42:43], v[126:127], v[42:43], v[166:167]
    v_cvt_pk_bf16_f32 v40, v40, v41
    v_cvt_pk_bf16_f32 v41, v42, v43
    ds_write_b64 v11, v[40:41] offset:3072
    s_waitcnt lgkmcnt(2)
    v_and_b32 v160, s36, v133
    v_lshlrev_b32 v161, 16, v133
    v_and_b32 v162, s36, v132
    v_lshlrev_b32 v163, 16, v132
    v_lshlrev_b32 v164, 16, v134
    v_and_b32 v165, s36, v134
    v_lshlrev_b32 v166, 16, v135
    v_and_b32 v167, s36, v135
    v_pk_fma_f32 v[44:45], v[160:161], v[4:5], v[44:45]
    v_pk_fma_f32 v[46:47], v[162:163], v[4:5], v[46:47]
    v_pk_fma_f32 v[136:137], v[164:165], v[136:137], v[140:141]
    v_pk_fma_f32 v[138:139], v[166:167], v[138:139], v[142:143]
    v_pk_fma_f32 v[44:45], v[136:137], v[44:45], v[164:165]
    v_pk_fma_f32 v[46:47], v[138:139], v[46:47], v[166:167]
    v_cvt_pk_bf16_f32 v44, v44, v45
    v_cvt_pk_bf16_f32 v45, v46, v47
    ds_write_b64 v11, v[44:45] offset:3584
    v_bfe_u32 v6, v1, 2, 2
    v_mul_u32_u24 v6, 8512, v6
    v_and_b32 v7, 3, v1
    v_lshl_add_u32 v6, v7, 3, v6
    v_lshl_add_u32 v6, v15, 5, v6
    s_lshl_b32 s41, s81, 10
    v_add_u32 v6, s41, v6
    s_lshr_b32 s42, s3, 1
    s_mul_i32 s42, s42, 33280
    s_and_b32 s43, s3, 1
    s_lshl_b32 s43, s43, 3
    s_add_u32 s42, s42, s43
    s_lshl_b32 s41, s81, 13
    s_add_u32 s42, s42, s41
    s_add_u32 s43, s42, 4096
    s_waitcnt lgkmcnt(0)
    s_barrier
    ds_read_b64_tr_b16 v[16:17], v6 offset:37376
    ds_read_b64_tr_b16 v[18:19], v6 offset:37504
    ds_read_b64_tr_b16 v[20:21], v6 offset:37632
    ds_read_b64_tr_b16 v[22:23], v6 offset:37760
    ds_read_b64_tr_b16 v[24:25], v6 offset:37888
    ds_read_b64_tr_b16 v[26:27], v6 offset:38016
    ds_read_b64_tr_b16 v[28:29], v6 offset:38144
    ds_read_b64_tr_b16 v[30:31], v6 offset:38272
    s_waitcnt lgkmcnt(7)
    buffer_store_dwordx2 v[16:17], v2, s[32:35], s42 offen offset:0
    s_waitcnt lgkmcnt(6)
    buffer_store_dwordx2 v[18:19], v2, s[32:35], s42 offen offset:1024
    s_waitcnt lgkmcnt(5)
    buffer_store_dwordx2 v[20:21], v2, s[32:35], s42 offen offset:2048
    s_waitcnt lgkmcnt(4)
    buffer_store_dwordx2 v[22:23], v2, s[32:35], s42 offen offset:3072
    s_waitcnt lgkmcnt(3)
    buffer_store_dwordx2 v[24:25], v2, s[32:35], s43 offen offset:0
    s_waitcnt lgkmcnt(2)
    buffer_store_dwordx2 v[26:27], v2, s[32:35], s43 offen offset:1024
    s_waitcnt lgkmcnt(1)
    buffer_store_dwordx2 v[28:29], v2, s[32:35], s43 offen offset:2048
    s_waitcnt lgkmcnt(0)
    buffer_store_dwordx2 v[30:31], v2, s[32:35], s43 offen offset:3072
    s_endpgm
k1_aux0:
    s_sub_u32 s3, s2, 160
    s_and_b32 s14, s3, 7
    s_mul_i32 s14, s14, 327680
    s_lshr_b32 s3, s3, 3
    s_mul_i32 s3, s3, 27392
    s_add_u32 s14, s14, s3
    v_lshlrev_b32 v1, 7, v0
    buffer_load_dword v100, v1, s[44:47], s14 offen
k1_aux:
    s_cmp_ge_u32 s2, 216
    s_cbranch_scc1 k1_pre
    s_sub_u32 s3, s2, 160
    s_and_b32 s14, s3, 1
    s_mul_i32 s14, s14, 14
    s_lshr_b32 s15, s3, 2
    s_add_u32 s14, s14, s15
    s_cmp_ge_u32 s14, 27
    s_cbranch_scc1 k1_end
    s_load_dwordx4 s[4:7], s[0:1], 56
    s_load_dwordx2 s[12:13], s[0:1], 96
    v_lshrrev_b32 v1, 3, v0
    v_and_b32 v2, 7, v0
    v_mul_u32_u24 v1, 3456, v1
    v_lshl_add_u32 v1, v2, 4, v1
    s_lshl_b32 s15, s14, 7
    s_bitcmp1_b32 s3, 1
    s_waitcnt lgkmcnt(0)
    s_cselect_b32 s16, s6, s4
    s_cselect_b32 s17, s7, s5
    s_cselect_b32 s40, 13824, 0
    s_mov_b32 s18, 0x21c000
    s_mov_b32 s19, 0x20000
    s_add_u32 s20, s12, 0x518000
    s_addc_u32 s21, s13, 0
    s_mov_b32 s22, 0x6c00
    s_mov_b32 s23, 0x20000
    buffer_load_dwordx4 v[16:19], v1, s[16:19], s15 offen
    s_add_u32 s15, s15, 110592
    buffer_load_dwordx4 v[20:23], v1, s[16:19], s15 offen
    s_add_u32 s15, s15, 110592
    buffer_load_dwordx4 v[24:27], v1, s[16:19], s15 offen
    s_add_u32 s15, s15, 110592
    buffer_load_dwordx4 v[28:31], v1, s[16:19], s15 offen
    s_add_u32 s15, s15, 110592
    buffer_load_dwordx4 v[32:35], v1, s[16:19], s15 offen
    s_add_u32 s15, s15, 110592
    buffer_load_dwordx4 v[36:39], v1, s[16:19], s15 offen
    s_add_u32 s15, s15, 110592
    buffer_load_dwordx4 v[40:43], v1, s[16:19], s15 offen
    s_add_u32 s15, s15, 110592
    buffer_load_dwordx4 v[44:47], v1, s[16:19], s15 offen
    s_add_u32 s15, s15, 110592
    buffer_load_dwordx4 v[48:51], v1, s[16:19], s15 offen
    s_add_u32 s15, s15, 110592
    buffer_load_dwordx4 v[52:55], v1, s[16:19], s15 offen
    s_add_u32 s15, s15, 110592
    buffer_load_dwordx4 v[56:59], v1, s[16:19], s15 offen
    s_add_u32 s15, s15, 110592
    buffer_load_dwordx4 v[60:63], v1, s[16:19], s15 offen
    s_add_u32 s15, s15, 110592
    buffer_load_dwordx4 v[64:67], v1, s[16:19], s15 offen
    s_add_u32 s15, s15, 110592
    buffer_load_dwordx4 v[68:71], v1, s[16:19], s15 offen
    s_add_u32 s15, s15, 110592
    buffer_load_dwordx4 v[72:75], v1, s[16:19], s15 offen
    s_add_u32 s15, s15, 110592
    buffer_load_dwordx4 v[76:79], v1, s[16:19], s15 offen
    s_add_u32 s15, s15, 110592
    buffer_load_dwordx4 v[80:83], v1, s[16:19], s15 offen
    s_add_u32 s15, s15, 110592
    buffer_load_dwordx4 v[84:87], v1, s[16:19], s15 offen
    s_add_u32 s15, s15, 110592
    buffer_load_dwordx4 v[88:91], v1, s[16:19], s15 offen
    s_add_u32 s15, s15, 110592
    buffer_load_dwordx4 v[92:95], v1, s[16:19], s15 offen
    s_add_u32 s15, s15, 110592
    s_mov_b32 s36, 0x3f80
    s_mov_b32 s37, 0x3f800000
    v_lshlrev_b32 v3, 5, v0
    v_lshlrev_b32 v4, 2, v0
    v_mov_b32 v8, 0
    v_mov_b32 v9, 0
    v_mov_b32 v10, 0
    v_mov_b32 v11, 0
    v_mov_b32 v12, 0
    v_mov_b32 v13, 0
    v_mov_b32 v14, 0
    v_mov_b32 v15, 0
    s_waitcnt vmcnt(19)
    v_dot2c_f32_bf16 v8, s36, v16
    v_dot2c_f32_bf16 v9, s37, v16
    v_dot2c_f32_bf16 v10, s36, v17
    v_dot2c_f32_bf16 v11, s37, v17
    v_dot2c_f32_bf16 v12, s36, v18
    v_dot2c_f32_bf16 v13, s37, v18
    v_dot2c_f32_bf16 v14, s36, v19
    v_dot2c_f32_bf16 v15, s37, v19
    s_waitcnt vmcnt(18)
    v_dot2c_f32_bf16 v8, s36, v20
    v_dot2c_f32_bf16 v9, s37, v20
    v_dot2c_f32_bf16 v10, s36, v21
    v_dot2c_f32_bf16 v11, s37, v21
    v_dot2c_f32_bf16 v12, s36, v22
    v_dot2c_f32_bf16 v13, s37, v22
    v_dot2c_f32_bf16 v14, s36, v23
    v_dot2c_f32_bf16 v15, s37, v23
    s_waitcnt vmcnt(17)
    v_dot2c_f32_bf16 v8, s36, v24
    v_dot2c_f32_bf16 v9, s37, v24
    v_dot2c_f32_bf16 v10, s36, v25
    v_dot2c_f32_bf16 v11, s37, v25
    v_dot2c_f32_bf16 v12, s36, v26
    v_dot2c_f32_bf16 v13, s37, v26
    v_dot2c_f32_bf16 v14, s36, v27
    v_dot2c_f32_bf16 v15, s37, v27
    s_waitcnt vmcnt(16)
    v_dot2c_f32_bf16 v8, s36, v28
    v_dot2c_f32_bf16 v9, s37, v28
    v_dot2c_f32_bf16 v10, s36, v29
    v_dot2c_f32_bf16 v11, s37, v29
    v_dot2c_f32_bf16 v12, s36, v30
    v_dot2c_f32_bf16 v13, s37, v30
    v_dot2c_f32_bf16 v14, s36, v31
    v_dot2c_f32_bf16 v15, s37, v31
    s_waitcnt vmcnt(15)
    v_dot2c_f32_bf16 v8, s36, v32
    v_dot2c_f32_bf16 v9, s37, v32
    v_dot2c_f32_bf16 v10, s36, v33
    v_dot2c_f32_bf16 v11, s37, v33
    v_dot2c_f32_bf16 v12, s36, v34
    v_dot2c_f32_bf16 v13, s37, v34
    v_dot2c_f32_bf16 v14, s36, v35
    v_dot2c_f32_bf16 v15, s37, v35
    s_waitcnt vmcnt(14)
    v_dot2c_f32_bf16 v8, s36, v36
    v_dot2c_f32_bf16 v9, s37, v36
    v_dot2c_f32_bf16 v10, s36, v37
    v_dot2c_f32_bf16 v11, s37, v37
    v_dot2c_f32_bf16 v12, s36, v38
    v_dot2c_f32_bf16 v13, s37, v38
    v_dot2c_f32_bf16 v14, s36, v39
    v_dot2c_f32_bf16 v15, s37, v39
    s_waitcnt vmcnt(13)
    v_dot2c_f32_bf16 v8, s36, v40
    v_dot2c_f32_bf16 v9, s37, v40
    v_dot2c_f32_bf16 v10, s36, v41
    v_dot2c_f32_bf16 v11, s37, v41
    v_dot2c_f32_bf16 v12, s36, v42
    v_dot2c_f32_bf16 v13, s37, v42
    v_dot2c_f32_bf16 v14, s36, v43
    v_dot2c_f32_bf16 v15, s37, v43
    s_waitcnt vmcnt(12)
    v_dot2c_f32_bf16 v8, s36, v44
    v_dot2c_f32_bf16 v9, s37, v44
    v_dot2c_f32_bf16 v10, s36, v45
    v_dot2c_f32_bf16 v11, s37, v45
    v_dot2c_f32_bf16 v12, s36, v46
    v_dot2c_f32_bf16 v13, s37, v46
    v_dot2c_f32_bf16 v14, s36, v47
    v_dot2c_f32_bf16 v15, s37, v47
    s_waitcnt vmcnt(11)
    v_dot2c_f32_bf16 v8, s36, v48
    v_dot2c_f32_bf16 v9, s37, v48
    v_dot2c_f32_bf16 v10, s36, v49
    v_dot2c_f32_bf16 v11, s37, v49
    v_dot2c_f32_bf16 v12, s36, v50
    v_dot2c_f32_bf16 v13, s37, v50
    v_dot2c_f32_bf16 v14, s36, v51
    v_dot2c_f32_bf16 v15, s37, v51
    s_waitcnt vmcnt(10)
    v_dot2c_f32_bf16 v8, s36, v52
    v_dot2c_f32_bf16 v9, s37, v52
    v_dot2c_f32_bf16 v10, s36, v53
    v_dot2c_f32_bf16 v11, s37, v53
    v_dot2c_f32_bf16 v12, s36, v54
    v_dot2c_f32_bf16 v13, s37, v54
    v_dot2c_f32_bf16 v14, s36, v55
    v_dot2c_f32_bf16 v15, s37, v55
    s_waitcnt vmcnt(9)
    v_dot2c_f32_bf16 v8, s36, v56
    v_dot2c_f32_bf16 v9, s37, v56
    v_dot2c_f32_bf16 v10, s36, v57
    v_dot2c_f32_bf16 v11, s37, v57
    v_dot2c_f32_bf16 v12, s36, v58
    v_dot2c_f32_bf16 v13, s37, v58
    v_dot2c_f32_bf16 v14, s36, v59
    v_dot2c_f32_bf16 v15, s37, v59
    s_waitcnt vmcnt(8)
    v_dot2c_f32_bf16 v8, s36, v60
    v_dot2c_f32_bf16 v9, s37, v60
    v_dot2c_f32_bf16 v10, s36, v61
    v_dot2c_f32_bf16 v11, s37, v61
    v_dot2c_f32_bf16 v12, s36, v62
    v_dot2c_f32_bf16 v13, s37, v62
    v_dot2c_f32_bf16 v14, s36, v63
    v_dot2c_f32_bf16 v15, s37, v63
    s_waitcnt vmcnt(7)
    v_dot2c_f32_bf16 v8, s36, v64
    v_dot2c_f32_bf16 v9, s37, v64
    v_dot2c_f32_bf16 v10, s36, v65
    v_dot2c_f32_bf16 v11, s37, v65
    v_dot2c_f32_bf16 v12, s36, v66
    v_dot2c_f32_bf16 v13, s37, v66
    v_dot2c_f32_bf16 v14, s36, v67
    v_dot2c_f32_bf16 v15, s37, v67
    s_waitcnt vmcnt(6)
    v_dot2c_f32_bf16 v8, s36, v68
    v_dot2c_f32_bf16 v9, s37, v68
    v_dot2c_f32_bf16 v10, s36, v69
    v_dot2c_f32_bf16 v11, s37, v69
    v_dot2c_f32_bf16 v12, s36, v70
    v_dot2c_f32_bf16 v13, s37, v70
    v_dot2c_f32_bf16 v14, s36, v71
    v_dot2c_f32_bf16 v15, s37, v71
    s_waitcnt vmcnt(5)
    v_dot2c_f32_bf16 v8, s36, v72
    v_dot2c_f32_bf16 v9, s37, v72
    v_dot2c_f32_bf16 v10, s36, v73
    v_dot2c_f32_bf16 v11, s37, v73
    v_dot2c_f32_bf16 v12, s36, v74
    v_dot2c_f32_bf16 v13, s37, v74
    v_dot2c_f32_bf16 v14, s36, v75
    v_dot2c_f32_bf16 v15, s37, v75
    s_waitcnt vmcnt(4)
    v_dot2c_f32_bf16 v8, s36, v76
    v_dot2c_f32_bf16 v9, s37, v76
    v_dot2c_f32_bf16 v10, s36, v77
    v_dot2c_f32_bf16 v11, s37, v77
    v_dot2c_f32_bf16 v12, s36, v78
    v_dot2c_f32_bf16 v13, s37, v78
    v_dot2c_f32_bf16 v14, s36, v79
    v_dot2c_f32_bf16 v15, s37, v79
    s_waitcnt vmcnt(3)
    v_dot2c_f32_bf16 v8, s36, v80
    v_dot2c_f32_bf16 v9, s37, v80
    v_dot2c_f32_bf16 v10, s36, v81
    v_dot2c_f32_bf16 v11, s37, v81
    v_dot2c_f32_bf16 v12, s36, v82
    v_dot2c_f32_bf16 v13, s37, v82
    v_dot2c_f32_bf16 v14, s36, v83
    v_dot2c_f32_bf16 v15, s37, v83
    s_waitcnt vmcnt(2)
    v_dot2c_f32_bf16 v8, s36, v84
    v_dot2c_f32_bf16 v9, s37, v84
    v_dot2c_f32_bf16 v10, s36, v85
    v_dot2c_f32_bf16 v11, s37, v85
    v_dot2c_f32_bf16 v12, s36, v86
    v_dot2c_f32_bf16 v13, s37, v86
    v_dot2c_f32_bf16 v14, s36, v87
    v_dot2c_f32_bf16 v15, s37, v87
    s_waitcnt vmcnt(1)
    v_dot2c_f32_bf16 v8, s36, v88
    v_dot2c_f32_bf16 v9, s37, v88
    v_dot2c_f32_bf16 v10, s36, v89
    v_dot2c_f32_bf16 v11, s37, v89
    v_dot2c_f32_bf16 v12, s36, v90
    v_dot2c_f32_bf16 v13, s37, v90
    v_dot2c_f32_bf16 v14, s36, v91
    v_dot2c_f32_bf16 v15, s37, v91
    s_waitcnt vmcnt(0)
    v_dot2c_f32_bf16 v8, s36, v92
    v_dot2c_f32_bf16 v9, s37, v92
    v_dot2c_f32_bf16 v10, s36, v93
    v_dot2c_f32_bf16 v11, s37, v93
    v_dot2c_f32_bf16 v12, s36, v94
    v_dot2c_f32_bf16 v13, s37, v94
    v_dot2c_f32_bf16 v14, s36, v95
    v_dot2c_f32_bf16 v15, s37, v95
    s_nop 2
    ds_write_b128 v3, v[8:11]
    ds_write_b128 v3, v[12:15] offset:16
    v_readfirstlane_b32 s81, v0
    s_waitcnt lgkmcnt(0)
    s_barrier
    s_cmp_lg_u32 s81, 0
    s_cbranch_scc1 k1_end
    ds_read2st64_b32 v[16:17], v4 offset0:0 offset1:1
    ds_read2st64_b32 v[18:19], v4 offset0:2 offset1:3
    ds_read2st64_b32 v[20:21], v4 offset0:4 offset1:5
    ds_read2st64_b32 v[22:23], v4 offset0:6 offset1:7
    ds_read2st64_b32 v[24:25], v4 offset0:8 offset1:9
    ds_read2st64_b32 v[26:27], v4 offset0:10 offset1:11
    ds_read2st64_b32 v[28:29], v4 offset0:12 offset1:13
    ds_read2st64_b32 v[30:31], v4 offset0:14 offset1:15
    ds_read2st64_b32 v[32:33], v4 offset0:16 offset1:17
    ds_read2st64_b32 v[34:35], v4 offset0:18 offset1:19
    ds_read2st64_b32 v[36:37], v4 offset0:20 offset1:21
    ds_read2st64_b32 v[38:39], v4 offset0:22 offset1:23
    ds_read2st64_b32 v[40:41], v4 offset0:24 offset1:25
    ds_read2st64_b32 v[42:43], v4 offset0:26 offset1:27
    ds_read2st64_b32 v[44:45], v4 offset0:28 offset1:29
    ds_read2st64_b32 v[46:47], v4 offset0:30 offset1:31
    s_waitcnt lgkmcnt(0)
    v_pk_add_f32 v[16:17], v[16:17], v[32:33]
    v_pk_add_f32 v[18:19], v[18:19], v[34:35]
    v_pk_add_f32 v[20:21], v[20:21], v[36:37]
    v_pk_add_f32 v[22:23], v[22:23], v[38:39]
    v_pk_add_f32 v[24:25], v[24:25], v[40:41]
    v_pk_add_f32 v[26:27], v[26:27], v[42:43]
    v_pk_add_f32 v[28:29], v[28:29], v[44:45]
    v_pk_add_f32 v[30:31], v[30:31], v[46:47]
    v_pk_add_f32 v[16:17], v[16:17], v[24:25]
    v_pk_add_f32 v[18:19], v[18:19], v[26:27]
    v_pk_add_f32 v[20:21], v[20:21], v[28:29]
    v_pk_add_f32 v[22:23], v[22:23], v[30:31]
    v_pk_add_f32 v[16:17], v[16:17], v[20:21]
    v_pk_add_f32 v[18:19], v[18:19], v[22:23]
    v_pk_add_f32 v[16:17], v[16:17], v[18:19]
    s_lshl_b32 s14, s14, 9
    s_add_u32 s14, s14, s40
    v_add_f32 v16, v16, v17
    v_cvt_pk_bf16_f32 v8, v16, v16
    v_lshlrev_b32 v17, 16, v8
    v_sub_f32 v16, v16, v17
    v_cvt_pk_bf16_f32 v9, v16, v16
    v_lshlrev_b32 v4, 3, v0
    buffer_store_dwordx2 v[8:9], v4, s[20:23], s14 offen
    s_endpgm
k1_pre:
    s_cmp_ge_u32 s2, 252
    s_cbranch_scc1 k1_end
    s_load_dwordx2 s[16:17], s[0:1], 72
    s_load_dwordx2 s[12:13], s[0:1], 96
    s_sub_u32 s3, s2, 216
    s_mul_i32 s3, s3, 3
    v_and_b32 v1, 63, v0
    v_lshrrev_b32 v7, 2, v1
    v_mul_u32_u24 v7, 640, v7
    v_and_b32 v8, 3, v1
    v_lshl_add_u32 v7, v8, 3, v7
    s_mul_i32 s15, s81, 160
    v_add_u32 v7, s15, v7
    v_lshlrev_b32 v1, 4, v1
    s_lshl_b32 s40, s81, 10
    v_add_u32 v8, 0, v0
    v_mul_u32_u24 v9, 1639, v8
    v_lshrrev_b32 v9, 16, v9
    v_mul_u32_u24 v9, 640, v9
    v_lshl_add_u32 v2, v8, 4, v9
    v_add_u32 v8, 256, v0
    v_mul_u32_u24 v9, 1639, v8
    v_lshrrev_b32 v9, 16, v9
    v_mul_u32_u24 v9, 640, v9
    v_lshl_add_u32 v3, v8, 4, v9
    v_add_u32 v8, 512, v0
    v_mul_u32_u24 v9, 1639, v8
    v_lshrrev_b32 v9, 16, v9
    v_mul_u32_u24 v9, 640, v9
    v_lshl_add_u32 v4, v8, 4, v9
    v_add_u32 v8, 768, v0
    v_mul_u32_u24 v9, 1639, v8
    v_lshrrev_b32 v9, 16, v9
    v_mul_u32_u24 v9, 640, v9
    v_lshl_add_u32 v5, v8, 4, v9
    v_add_u32 v8, 1024, v0
    v_mul_u32_u24 v9, 1639, v8
    v_lshrrev_b32 v9, 16, v9
    v_mul_u32_u24 v9, 640, v9
    v_lshl_add_u32 v6, v8, 4, v9
    s_waitcnt lgkmcnt(0)
    s_mov_b32 s18, 0x21c000
    s_mov_b32 s19, 0x20000
    s_add_u32 s20, s12, 0x1000000
    s_addc_u32 s21, s13, 0
    s_mov_b32 s22, 0x21c000
    s_mov_b32 s23, 0x20000
    s_add_u32 s14, s3, 0
    s_and_b32 s15, s14, 1
    s_lshr_b32 s14, s14, 1
    s_mul_i32 s36, s14, 5120
    s_mul_i32 s14, s14, 40960
    s_mul_i32 s41, s15, 640
    s_add_u32 s14, s14, s41
    s_lshl_b32 s15, s15, 2
    s_add_u32 s15, s15, s81
    s_mul_i32 s15, s15, 276480
    s_add_u32 s36, s36, s15
    s_add_u32 m0, s40, 0
    s_nop 0
    buffer_load_dwordx4 v2, s[16:19], s14 offen lds
    s_add_u32 m0, s40, 4096
    s_nop 0
    buffer_load_dwordx4 v3, s[16:19], s14 offen lds
    s_add_u32 m0, s40, 8192
    s_nop 0
    buffer_load_dwordx4 v4, s[16:19], s14 offen lds
    s_add_u32 m0, s40, 12288
    s_nop 0
    buffer_load_dwordx4 v5, s[16:19], s14 offen lds
    s_add_u32 m0, s40, 16384
    s_nop 0
    buffer_load_dwordx4 v6, s[16:19], s14 offen lds
    s_add_u32 s14, s3, 1
    s_and_b32 s15, s14, 1
    s_lshr_b32 s14, s14, 1
    s_mul_i32 s37, s14, 5120
    s_mul_i32 s14, s14, 40960
    s_mul_i32 s41, s15, 640
    s_add_u32 s14, s14, s41
    s_lshl_b32 s15, s15, 2
    s_add_u32 s15, s15, s81
    s_mul_i32 s15, s15, 276480
    s_add_u32 s37, s37, s15
    s_add_u32 m0, s40, 20480
    s_nop 0
    buffer_load_dwordx4 v2, s[16:19], s14 offen lds
    s_add_u32 m0, s40, 24576
    s_nop 0
    buffer_load_dwordx4 v3, s[16:19], s14 offen lds
    s_add_u32 m0, s40, 28672
    s_nop 0
    buffer_load_dwordx4 v4, s[16:19], s14 offen lds
    s_add_u32 m0, s40, 32768
    s_nop 0
    buffer_load_dwordx4 v5, s[16:19], s14 offen lds
    s_add_u32 m0, s40, 36864
    s_nop 0
    buffer_load_dwordx4 v6, s[16:19], s14 offen lds
    s_add_u32 s14, s3, 2
    s_and_b32 s15, s14, 1
    s_lshr_b32 s14, s14, 1
    s_mul_i32 s38, s14, 5120
    s_mul_i32 s14, s14, 40960
    s_mul_i32 s41, s15, 640
    s_add_u32 s14, s14, s41
    s_lshl_b32 s15, s15, 2
    s_add_u32 s15, s15, s81
    s_mul_i32 s15, s15, 276480
    s_add_u32 s38, s38, s15
    s_add_u32 m0, s40, 40960
    s_nop 0
    buffer_load_dwordx4 v2, s[16:19], s14 offen lds
    s_add_u32 m0, s40, 45056
    s_nop 0
    buffer_load_dwordx4 v3, s[16:19], s14 offen lds
    s_add_u32 m0, s40, 49152
    s_nop 0
    buffer_load_dwordx4 v4, s[16:19], s14 offen lds
    s_add_u32 m0, s40, 53248
    s_nop 0
    buffer_load_dwordx4 v5, s[16:19], s14 offen lds
    s_add_u32 m0, s40, 57344
    s_nop 0
    buffer_load_dwordx4 v6, s[16:19], s14 offen lds
    s_waitcnt vmcnt(10)
    s_barrier
    ds_read_b64_tr_b16 v[16:17], v7 offset:0
    ds_read_b64_tr_b16 v[18:19], v7 offset:10240
    ds_read_b64_tr_b16 v[20:21], v7 offset:32
    ds_read_b64_tr_b16 v[22:23], v7 offset:10272
    ds_read_b64_tr_b16 v[24:25], v7 offset:64
    ds_read_b64_tr_b16 v[26:27], v7 offset:10304
    ds_read_b64_tr_b16 v[28:29], v7 offset:96
    ds_read_b64_tr_b16 v[30:31], v7 offset:10336
    ds_read_b64_tr_b16 v[32:33], v7 offset:128
    ds_read_b64_tr_b16 v[34:35], v7 offset:10368
    s_waitcnt vmcnt(5)
    s_barrier
    ds_read_b64_tr_b16 v[36:37], v7 offset:20480
    ds_read_b64_tr_b16 v[38:39], v7 offset:30720
    ds_read_b64_tr_b16 v[40:41], v7 offset:20512
    ds_read_b64_tr_b16 v[42:43], v7 offset:30752
    ds_read_b64_tr_b16 v[44:45], v7 offset:20544
    ds_read_b64_tr_b16 v[46:47], v7 offset:30784
    ds_read_b64_tr_b16 v[48:49], v7 offset:20576
    ds_read_b64_tr_b16 v[50:51], v7 offset:30816
    ds_read_b64_tr_b16 v[52:53], v7 offset:20608
    ds_read_b64_tr_b16 v[54:55], v7 offset:30848
    s_waitcnt vmcnt(0)
    s_barrier
    ds_read_b64_tr_b16 v[56:57], v7 offset:40960
    ds_read_b64_tr_b16 v[58:59], v7 offset:51200
    ds_read_b64_tr_b16 v[60:61], v7 offset:40992
    ds_read_b64_tr_b16 v[62:63], v7 offset:51232
    ds_read_b64_tr_b16 v[64:65], v7 offset:41024
    ds_read_b64_tr_b16 v[66:67], v7 offset:51264
    ds_read_b64_tr_b16 v[68:69], v7 offset:41056
    ds_read_b64_tr_b16 v[70:71], v7 offset:51296
    ds_read_b64_tr_b16 v[72:73], v7 offset:41088
    ds_read_b64_tr_b16 v[74:75], v7 offset:51328
    s_waitcnt lgkmcnt(10)
    buffer_store_dwordx4 v[16:19], v1, s[20:23], s36 offen offset:0 sc1
    buffer_store_dwordx4 v[20:23], v1, s[20:23], s36 offen offset:1024 sc1
    buffer_store_dwordx4 v[24:27], v1, s[20:23], s36 offen offset:2048 sc1
    buffer_store_dwordx4 v[28:31], v1, s[20:23], s36 offen offset:3072 sc1
    s_add_u32 s36, s36, 4096
    buffer_store_dwordx4 v[32:35], v1, s[20:23], s36 offen offset:0 sc1
    s_waitcnt lgkmcnt(10)
    buffer_store_dwordx4 v[36:39], v1, s[20:23], s37 offen offset:0 sc1
    buffer_store_dwordx4 v[40:43], v1, s[20:23], s37 offen offset:1024 sc1
    buffer_store_dwordx4 v[44:47], v1, s[20:23], s37 offen offset:2048 sc1
    buffer_store_dwordx4 v[48:51], v1, s[20:23], s37 offen offset:3072 sc1
    s_add_u32 s37, s37, 4096
    buffer_store_dwordx4 v[52:55], v1, s[20:23], s37 offen offset:0 sc1
    s_waitcnt lgkmcnt(0)
    buffer_store_dwordx4 v[56:59], v1, s[20:23], s38 offen offset:0 sc1
    buffer_store_dwordx4 v[60:63], v1, s[20:23], s38 offen offset:1024 sc1
    buffer_store_dwordx4 v[64:67], v1, s[20:23], s38 offen offset:2048 sc1
    buffer_store_dwordx4 v[68:71], v1, s[20:23], s38 offen offset:3072 sc1
    s_add_u32 s38, s38, 4096
    buffer_store_dwordx4 v[72:75], v1, s[20:23], s38 offen offset:0 sc1
k1_end:
    s_endpgm
    s_endpgm
k0_stats:
    s_add_u32 s32, s12, 0x510000
    s_addc_u32 s33, s13, 0
    s_mov_b32 s34, 0x8000
    s_mov_b32 s35, 0x20000
    s_add_u32 s60, s12, 0x1300000
    s_addc_u32 s61, s13, 0
    s_mov_b32 s62, 0x80000
    s_mov_b32 s63, 0x20000
    s_load_dword s65, s[60:61], 0x7ff00
    v_and_b32 v1, 63, v0
    v_lshrrev_b32 v2, 3, v1
    v_and_b32 v3, 7, v1
    v_mul_u32_u24 v4, 1280, v2
    v_lshl_add_u32 v4, v3, 4, v4
    buffer_load_dwordx4 v[8:11], v4, s[16:19], s14 offen offset:0
    buffer_load_dwordx4 v[12:15], v4, s[16:19], s14 offen offset:128
    buffer_load_dwordx4 v[16:19], v4, s[16:19], s14 offen offset:256
    buffer_load_dwordx4 v[20:23], v4, s[16:19], s14 offen offset:384
    buffer_load_dwordx4 v[24:27], v4, s[16:19], s14 offen offset:512
    buffer_load_dwordx4 v[28:31], v4, s[16:19], s14 offen offset:640
    buffer_load_dwordx4 v[32:35], v4, s[16:19], s14 offen offset:768
    buffer_load_dwordx4 v[36:39], v4, s[16:19], s14 offen offset:896
    buffer_load_dwordx4 v[40:43], v4, s[16:19], s14 offen offset:1024
    buffer_load_dwordx4 v[44:47], v4, s[16:19], s14 offen offset:1152
    s_lshl_b32 s15, s3, 5
    v_lshl_add_u32 v5, v2, 2, s15
    v_and_b32 v3, 1, v3
    v_lshlrev_b32 v52, 1, v5
    v_lshl_add_u32 v52, v3, 2, v52
    v_add_u32 v52, 0x4000, v52
    v_mov_b32 v53, -1
    v_add_u32 v5, s15, v5
    v_lshl_add_u32 v5, v3, 5, v5
    v_cmp_eq_u32 vcc, 1, v3
    s_mov_b32 s36, 0x3f803f80
    v_mov_b32 v6, 0
    v_mov_b32 v7, 0
    s_waitcnt vmcnt(9)
    v_dot2c_f32_bf16 v6, s36, v8
    v_dot2c_f32_bf16 v7, v8, v8
    v_dot2c_f32_bf16 v6, s36, v9
    v_dot2c_f32_bf16 v7, v9, v9
    v_dot2c_f32_bf16 v6, s36, v10
    v_dot2c_f32_bf16 v7, v10, v10
    v_dot2c_f32_bf16 v6, s36, v11
    v_dot2c_f32_bf16 v7, v11, v11
    s_waitcnt vmcnt(8)
    v_dot2c_f32_bf16 v6, s36, v12
    v_dot2c_f32_bf16 v7, v12, v12
    v_dot2c_f32_bf16 v6, s36, v13
    v_dot2c_f32_bf16 v7, v13, v13
    v_dot2c_f32_bf16 v6, s36, v14
    v_dot2c_f32_bf16 v7, v14, v14
    v_dot2c_f32_bf16 v6, s36, v15
    v_dot2c_f32_bf16 v7, v15, v15
    s_waitcnt vmcnt(7)
    v_dot2c_f32_bf16 v6, s36, v16
    v_dot2c_f32_bf16 v7, v16, v16
    v_dot2c_f32_bf16 v6, s36, v17
    v_dot2c_f32_bf16 v7, v17, v17
    v_dot2c_f32_bf16 v6, s36, v18
    v_dot2c_f32_bf16 v7, v18, v18
    v_dot2c_f32_bf16 v6, s36, v19
    v_dot2c_f32_bf16 v7, v19, v19
    s_waitcnt vmcnt(6)
    v_dot2c_f32_bf16 v6, s36, v20
    v_dot2c_f32_bf16 v7, v20, v20
    v_dot2c_f32_bf16 v6, s36, v21
    v_dot2c_f32_bf16 v7, v21, v21
    v_dot2c_f32_bf16 v6, s36, v22
    v_dot2c_f32_bf16 v7, v22, v22
    v_dot2c_f32_bf16 v6, s36, v23
    v_dot2c_f32_bf16 v7, v23, v23
    s_waitcnt vmcnt(5)
    v_dot2c_f32_bf16 v6, s36, v24
    v_dot2c_f32_bf16 v7, v24, v24
    v_dot2c_f32_bf16 v6, s36, v25
    v_dot2c_f32_bf16 v7, v25, v25
    v_dot2c_f32_bf16 v6, s36, v26
    v_dot2c_f32_bf16 v7, v26, v26
    v_dot2c_f32_bf16 v6, s36, v27
    v_dot2c_f32_bf16 v7, v27, v27
    s_waitcnt vmcnt(4)
    v_dot2c_f32_bf16 v6, s36, v28
    v_dot2c_f32_bf16 v7, v28, v28
    v_dot2c_f32_bf16 v6, s36, v29
    v_dot2c_f32_bf16 v7, v29, v29
    v_dot2c_f32_bf16 v6, s36, v30
    v_dot2c_f32_bf16 v7, v30, v30
    v_dot2c_f32_bf16 v6, s36, v31
    v_dot2c_f32_bf16 v7, v31, v31
    s_waitcnt vmcnt(3)
    v_dot2c_f32_bf16 v6, s36, v32
    v_dot2c_f32_bf16 v7, v32, v32
    v_dot2c_f32_bf16 v6, s36, v33
    v_dot2c_f32_bf16 v7, v33, v33
    v_dot2c_f32_bf16 v6, s36, v34
    v_dot2c_f32_bf16 v7, v34, v34
    v_dot2c_f32_bf16 v6, s36, v35
    v_dot2c_f32_bf16 v7, v35, v35
    s_waitcnt vmcnt(2)
    v_dot2c_f32_bf16 v6, s36, v36
    v_dot2c_f32_bf16 v7, v36, v36
    v_dot2c_f32_bf16 v6, s36, v37
    v_dot2c_f32_bf16 v7, v37, v37
    v_dot2c_f32_bf16 v6, s36, v38
    v_dot2c_f32_bf16 v7, v38, v38
    v_dot2c_f32_bf16 v6, s36, v39
    v_dot2c_f32_bf16 v7, v39, v39
    s_waitcnt vmcnt(1)
    v_dot2c_f32_bf16 v6, s36, v40
    v_dot2c_f32_bf16 v7, v40, v40
    v_dot2c_f32_bf16 v6, s36, v41
    v_dot2c_f32_bf16 v7, v41, v41
    v_dot2c_f32_bf16 v6, s36, v42
    v_dot2c_f32_bf16 v7, v42, v42
    v_dot2c_f32_bf16 v6, s36, v43
    v_dot2c_f32_bf16 v7, v43, v43
    s_waitcnt vmcnt(0)
    v_dot2c_f32_bf16 v6, s36, v44
    v_dot2c_f32_bf16 v7, v44, v44
    v_dot2c_f32_bf16 v6, s36, v45
    v_dot2c_f32_bf16 v7, v45, v45
    v_dot2c_f32_bf16 v6, s36, v46
    v_dot2c_f32_bf16 v7, v46, v46
    v_dot2c_f32_bf16 v6, s36, v47
    v_dot2c_f32_bf16 v7, v47, v47
    buffer_store_dword v53, v52, s[32:35], 0 offen
    s_nop 2
    v_add_f32_dpp v6, v6, v6 quad_perm:[1,0,3,2] row_mask:0xf bank_mask:0xf
    v_add_f32_dpp v7, v7, v7 quad_perm:[1,0,3,2] row_mask:0xf bank_mask:0xf
    s_nop 0
    v_add_f32_dpp v6, v6, v6 quad_perm:[2,3,0,1] row_mask:0xf bank_mask:0xf
    v_add_f32_dpp v7, v7, v7 quad_perm:[2,3,0,1] row_mask:0xf bank_mask:0xf
    s_nop 0
    v_add_f32_dpp v6, v6, v6 row_half_mirror row_mask:0xf bank_mask:0xf
    v_add_f32_dpp v7, v7, v7 row_half_mirror row_mask:0xf bank_mask:0xf
    s_nop 0
    v_mul_f32 v6, 0.0015625, v6
    v_mul_f32 v7, 0.0015625, v7
    v_fma_f32 v7, -v6, v6, v7
    v_max_f32 v7, 0, v7
    v_add_f32 v7, 0x3727c5ac, v7
    v_rsq_f32 v7, v7
    s_nop 0
    v_mul_f32 v6, -v6, v7
    v_cndmask_b32 v6, v7, v6, vcc
    buffer_store_dword v6, v5, s[32:35], 0 offen sc1
    s_and_b32 s38, s2, 31
    s_mul_i32 s38, s38, 4352
    v_mul_u32_u24 v3, 4352, v1
    v_lshlrev_b32 v4, 4, v1
    s_lshl_b32 s39, s2, 2
    s_mov_b32 s37, 0
    s_waitcnt lgkmcnt(0)
    s_mul_i32 s65, s65, 0x9e3779b1
    s_add_u32 s65, s65, 0x7f4a7c15
    v_mov_b32 v2, s65
    v_add_u32 v16, 0, v4
    v_cmp_ne_u32 vcc, s39, v16
    v_cndmask_b32 v16, 0, -1, vcc
    v_add_u32 v17, 4, v4
    v_cmp_ne_u32 vcc, s39, v17
    v_cndmask_b32 v17, 0, -1, vcc
    v_add_u32 v18, 8, v4
    v_cmp_ne_u32 vcc, s39, v18
    v_cndmask_b32 v18, 0, -1, vcc
    v_add_u32 v19, 12, v4
    v_cmp_ne_u32 vcc, s39, v19
    v_cndmask_b32 v19, 0, -1, vcc
    s_bfm_b64 exec, 32, 0
    s_waitcnt vmcnt(0)
    s_barrier
    buffer_store_dword v2, v3, s[60:63], s39 offen sc0 sc1
    s_mov_b64 exec, -1
    s_waitcnt vmcnt(0)
    s_cmp_ge_u32 s2, 160
    s_cbranch_scc1 k0_fin
k0_poll:
    buffer_load_dwordx4 v[8:11], v4, s[60:63], s38 offen sc0 sc1
    s_add_u32 s37, s37, 1
    s_bitcmp1_b32 s37, 20
    s_cbranch_scc1 k0_got
    s_waitcnt vmcnt(0)
    v_xor_b32 v8, v2, v8
    v_xor_b32 v9, v2, v9
    v_xor_b32 v10, v2, v10
    v_xor_b32 v11, v2, v11
    v_and_b32 v8, v16, v8
    v_and_b32 v9, v17, v9
    v_and_b32 v10, v18, v10
    v_and_b32 v11, v19, v11
    v_or3_b32 v8, v8, v9, v10
    v_or_b32 v8, v8, v11
    v_cmp_ne_u32 vcc, 0, v8
    s_cbranch_vccnz k0_poll
k0_got:
    s_barrier
    s_cmp_lg_u32 s2, 0
    s_cbranch_scc1 k0_fin
    s_mov_b32 s38, 0x7ff00
    buffer_store_dword v2, off, s[60:63], s38
k0_fin:
k0_end:
    s_endpgm
.globl back_kernel
.p2align 8
.type back_kernel,@function
back_kernel:
    s_cmp_ge_u32 s2, 256
    s_cbranch_scc1 k2_end
    s_load_dwordx4 s[4:7], s[0:1], 56
    s_load_dwordx2 s[12:13], s[0:1], 96
    s_getpc_b64 s[68:69]
k2_pc0:
    s_mov_b32 s70, code_end-k2_pc0
    s_mov_b32 s71, 0x20000
    v_lshlrev_b32 v1, 7, v0
    buffer_load_dword v15, v1, s[68:71], 0 offen
    v_lshrrev_b32 v1, 6, v0
    s_and_b32 s3, s2, 7
    s_lshr_b32 s14, s2, 3
    v_readfirstlane_b32 s81, v1
    v_and_b32 v1, 63, v0
    v_lshlrev_b32 v14, 4, v1
    s_cmp_lt_u32 s14, 4
    s_cbranch_scc1 k2_stats
    s_sub_u32 s14, s14, 4
    s_and_b32 s15, s3, 1
    s_mul_i32 s15, s15, 14
    s_lshr_b32 s40, s14, 1
    s_add_u32 s40, s40, s15
    s_cmp_ge_u32 s40, 27
    s_cbranch_scc1 k2_idle
    s_and_b32 s14, s14, 1
    s_and_b32 s3, s3, 6
    s_add_u32 s3, s3, s14
    s_lshl_b32 s3, s3, 2
    s_add_u32 s3, s3, s81
    v_lshrrev_b32 v3, 3, v1
    v_mul_u32_u24 v2, 3456, v3
    v_and_b32 v3, 2, v3
    v_and_b32 v4, 7, v1
    v_xor_b32 v3, v3, v4
    v_lshl_add_u32 v2, v3, 4, v2
    v_xor_b32 v3, 64, v2
    v_add_u32 v3, 27648, v3
    s_mul_i32 s41, s81, 55296
    s_lshl_b32 s15, s40, 7
    s_add_u32 s41, s41, s15
    s_lshl_b32 s42, s81, 11
    s_lshl_b32 s43, s3, 10
    v_lshrrev_b32 v5, 4, v1
    v_and_b32 v6, 15, v1
    v_mul_u32_u24 v4, 33280, v5
    v_lshl_add_u32 v4, v6, 4, v4
    v_lshlrev_b32 v7, 3, v6
    v_bfe_u32 v8, v1, 2, 2
    v_lshl_add_u32 v9, v5, 3, v8
    v_lshlrev_b32 v9, 7, v9
    v_bfe_u32 v8, v1, 3, 2
    v_lshl_add_u32 v9, v8, 5, v9
    v_and_b32 v8, 3, v1
    v_lshl_add_u32 v8, v8, 3, v9
    v_xor_b32 v9, 32, v8
    v_xor_b32 v10, 64, v8
    v_xor_b32 v11, 0x60, v8
    v_accvgpr_write_b32 a16, 0
    v_accvgpr_write_b32 a17, 0
    v_mov_b64 v[128:129], 0
    v_mov_b64 v[130:131], 0
    v_mov_b64 v[132:133], 0
    v_mov_b64 v[134:135], 0
    v_mov_b64 v[136:137], 0
    v_mov_b64 v[138:139], 0
    v_mov_b64 v[140:141], 0
    v_mov_b64 v[142:143], 0
    v_mov_b64 v[144:145], 0
    v_mov_b64 v[146:147], 0
    v_mov_b64 v[148:149], 0
    v_mov_b64 v[150:151], 0
    v_mov_b64 v[152:153], 0
    v_mov_b64 v[154:155], 0
    v_mov_b64 v[156:157], 0
    v_mov_b64 v[158:159], 0
    v_mov_b64 v[160:161], 0
    v_mov_b64 v[162:163], 0
    v_mov_b64 v[164:165], 0
    v_mov_b64 v[166:167], 0
    v_mov_b64 v[168:169], 0
    v_mov_b64 v[170:171], 0
    v_mov_b64 v[172:173], 0
    v_mov_b64 v[174:175], 0
    v_mov_b64 v[176:177], 0
    v_mov_b64 v[178:179], 0
    v_mov_b64 v[180:181], 0
    v_mov_b64 v[182:183], 0
    v_mov_b64 v[184:185], 0
    v_mov_b64 v[186:187], 0
    v_mov_b64 v[188:189], 0
    v_mov_b64 v[190:191], 0
    v_mov_b64 v[192:193], 0
    v_mov_b64 v[194:195], 0
    v_mov_b64 v[196:197], 0
    v_mov_b64 v[198:199], 0
    v_mov_b64 v[200:201], 0
    v_mov_b64 v[202:203], 0
    v_mov_b64 v[204:205], 0
    v_mov_b64 v[206:207], 0
    v_mov_b64 v[208:209], 0
    v_mov_b64 v[210:211], 0
    v_mov_b64 v[212:213], 0
    v_mov_b64 v[214:215], 0
    v_mov_b64 v[216:217], 0
    v_mov_b64 v[218:219], 0
    v_mov_b64 v[220:221], 0
    v_mov_b64 v[222:223], 0
    v_mov_b64 v[224:225], 0
    v_mov_b64 v[226:227], 0
    v_mov_b64 v[228:229], 0
    v_mov_b64 v[230:231], 0
    v_mov_b64 v[232:233], 0
    v_mov_b64 v[234:235], 0
    v_mov_b64 v[236:237], 0
    v_mov_b64 v[238:239], 0
    v_mov_b64 v[240:241], 0
    v_mov_b64 v[242:243], 0
    v_mov_b64 v[244:245], 0
    v_mov_b64 v[246:247], 0
    v_mov_b64 v[248:249], 0
    v_mov_b64 v[250:251], 0
    v_mov_b64 v[252:253], 0
    v_mov_b64 v[254:255], 0
    s_waitcnt lgkmcnt(0)
    s_mov_b32 s16, s4
    s_mov_b32 s17, s5
    s_mov_b32 s18, 0x21c000
    s_mov_b32 s19, 0x20000
    s_mov_b32 s20, s6
    s_mov_b32 s21, s7
    s_mov_b32 s22, 0x21c000
    s_mov_b32 s23, 0x20000
    s_add_u32 s24, s12, 0x520000
    s_addc_u32 s25, s13, 0
    s_mov_b32 s26, 0x28a000
    s_mov_b32 s27, 0x20000
    s_add_u32 m0, s42, 0
    s_nop 0
    buffer_load_dwordx4 v2, s[16:19], s41 offen lds
    s_add_u32 m0, s42, 1024
    s_nop 0
    buffer_load_dwordx4 v3, s[16:19], s41 offen lds
    s_add_u32 m0, s42, 8192
    s_nop 0
    buffer_load_dwordx4 v2, s[20:23], s41 offen lds
    s_add_u32 m0, s42, 9216
    s_nop 0
    buffer_load_dwordx4 v3, s[20:23], s41 offen lds
    s_add_u32 s41, s41, 221184
    s_add_u32 s42, s42, 0x4000
    s_and_b32 s42, s42, 0xffff
    buffer_load_dwordx4 v[64:67], v4, s[24:27], s43 offen offset:0
    buffer_load_dwordx4 v[68:71], v4, s[24:27], s43 offen offset:256
    buffer_load_dwordx4 v[72:75], v4, s[24:27], s43 offen offset:512
    buffer_load_dwordx4 v[76:79], v4, s[24:27], s43 offen offset:768
    s_add_u32 s43, s43, 133120
    s_add_u32 m0, s42, 0
    s_nop 0
    buffer_load_dwordx4 v2, s[16:19], s41 offen lds
    s_add_u32 m0, s42, 1024
    s_nop 0
    buffer_load_dwordx4 v3, s[16:19], s41 offen lds
    s_add_u32 m0, s42, 8192
    s_nop 0
    buffer_load_dwordx4 v2, s[20:23], s41 offen lds
    s_add_u32 m0, s42, 9216
    s_nop 0
    buffer_load_dwordx4 v3, s[20:23], s41 offen lds
    s_add_u32 s41, s41, 221184
    s_add_u32 s42, s42, 0x4000
    s_and_b32 s42, s42, 0xffff
    buffer_load_dwordx4 v[80:83], v4, s[24:27], s43 offen offset:0
    buffer_load_dwordx4 v[84:87], v4, s[24:27], s43 offen offset:256
    buffer_load_dwordx4 v[88:91], v4, s[24:27], s43 offen offset:512
    buffer_load_dwordx4 v[92:95], v4, s[24:27], s43 offen offset:768
    s_add_u32 s43, s43, 133120
    buffer_load_dwordx4 v[96:99], v4, s[24:27], s43 offen offset:0
    buffer_load_dwordx4 v[100:103], v4, s[24:27], s43 offen offset:256
    buffer_load_dwordx4 v[104:107], v4, s[24:27], s43 offen offset:512
    buffer_load_dwordx4 v[108:111], v4, s[24:27], s43 offen offset:768
    s_add_u32 s43, s43, 133120
    s_add_u32 m0, s42, 0
    s_nop 0
    buffer_load_dwordx4 v2, s[16:19], s41 offen lds
    s_add_u32 m0, s42, 1024
    s_nop 0
    buffer_load_dwordx4 v3, s[16:19], s41 offen lds
    s_add_u32 m0, s42, 8192
    s_nop 0
    buffer_load_dwordx4 v2, s[20:23], s41 offen lds
    s_add_u32 m0, s42, 9216
    s_nop 0
    buffer_load_dwordx4 v3, s[20:23], s41 offen lds
    s_add_u32 s41, s41, 221184
    s_add_u32 s42, s42, 0x4000
    s_and_b32 s42, s42, 0xffff
    s_add_u32 s60, s12, 0x1300000
    s_addc_u32 s61, s13, 0
    s_mov_b32 s62, 0x80000
    s_mov_b32 s63, 0x20000
    s_load_dword s65, s[60:61], 0x7ff00
    s_load_dwordx2 s[8:9], s[0:1], 80
    s_and_b32 s58, s2, 1
    s_lshl_b32 s56, s58, 2
    s_bfe_u32 s15, s2, 0x20003
    s_add_u32 s56, s56, s15
    s_and_b32 s55, s2, 6
    s_lshl_b32 s55, s55, 4
    s_lshr_b32 s15, s2, 3
    s_and_b32 s57, s15, 28
    s_add_u32 s55, s55, s57
    s_lshr_b32 s57, s55, 4
    s_lshl_b32 s57, s57, 1
    s_add_u32 s57, s57, s58
    s_lshl_b32 s57, s57, 4
    s_and_b32 s15, s15, 15
    s_add_u32 s57, s57, s15
    s_lshl_b32 s57, s57, 8
    s_add_u32 s57, s57, 262144
    s_add_u32 s55, s55, s81
    s_mul_i32 s15, s56, 276480
    s_add_u32 s15, s15, 16777216
    s_add_u32 s48, s12, s15
    s_addc_u32 s49, s13, 0
    s_mul_i32 s53, s81, 5120
    s_mov_b32 s50, 0x43800
    s_mov_b32 s51, 0x20000
    s_lshr_b32 s59, s3, 2
    s_lshl_b32 s59, s59, 13
    s_lshl_b32 s15, s40, 2
    s_add_u32 s59, s59, s15
    s_add_u32 s59, s59, 262144
    s_add_u32 s28, s12, 0x514000
    s_addc_u32 s29, s13, 0
    s_mov_b32 s30, 0xac00
    s_mov_b32 s31, 0x20000
    s_add_u32 s32, s12, 0x800000
    s_addc_u32 s33, s13, 0
    s_mov_b32 s34, 0x6c0000
    s_mov_b32 s35, 0x20000
    s_lshl_b32 s44, s40, 9
    s_add_u32 s44, s44, 0x4000
    s_add_u32 s45, s44, 13824
    s_lshl_b32 s46, s3, 9
    s_waitcnt vmcnt(20)
    s_barrier
    ds_read_b64_tr_b16 v[32:33], v8 offset:0
    ds_read_b64_tr_b16 v[34:35], v8 offset:512
    ds_read_b64_tr_b16 v[36:37], v9 offset:0
    ds_read_b64_tr_b16 v[38:39], v9 offset:512
    ds_read_b64_tr_b16 v[40:41], v10 offset:0
    ds_read_b64_tr_b16 v[42:43], v10 offset:512
    ds_read_b64_tr_b16 v[44:45], v11 offset:0
    ds_read_b64_tr_b16 v[46:47], v11 offset:512
    s_mov_b32 s47, 4
k2_loop:
    s_waitcnt vmcnt(13) lgkmcnt(0)
    v_mfma_f32_16x16x32_bf16 v[128:131], v[32:35], v[64:67], v[128:131]
    buffer_load_dwordx4 v[112:115], v4, s[24:27], s43 offen offset:0
    v_mfma_f32_16x16x32_bf16 v[144:147], v[32:35], v[68:71], v[144:147]
    ds_read_b64_tr_b16 v[48:49], v8 offset:8192
    v_mfma_f32_16x16x32_bf16 v[160:163], v[32:35], v[72:75], v[160:163]
    ds_read_b64_tr_b16 v[50:51], v8 offset:8704
    v_mfma_f32_16x16x32_bf16 v[176:179], v[32:35], v[76:79], v[176:179]
    ds_read_b64_tr_b16 v[52:53], v9 offset:8192
    v_mfma_f32_16x16x32_bf16 v[132:135], v[36:39], v[64:67], v[132:135]
    ds_read_b64_tr_b16 v[54:55], v9 offset:8704
    v_mfma_f32_16x16x32_bf16 v[148:151], v[36:39], v[68:71], v[148:151]
    buffer_load_dwordx4 v[116:119], v4, s[24:27], s43 offen offset:256
    v_mfma_f32_16x16x32_bf16 v[164:167], v[36:39], v[72:75], v[164:167]
    ds_read_b64_tr_b16 v[56:57], v10 offset:8192
    v_mfma_f32_16x16x32_bf16 v[180:183], v[36:39], v[76:79], v[180:183]
    ds_read_b64_tr_b16 v[58:59], v10 offset:8704
    v_mfma_f32_16x16x32_bf16 v[136:139], v[40:43], v[64:67], v[136:139]
    ds_read_b64_tr_b16 v[60:61], v11 offset:8192
    v_mfma_f32_16x16x32_bf16 v[152:155], v[40:43], v[68:71], v[152:155]
    ds_read_b64_tr_b16 v[62:63], v11 offset:8704
    s_add_u32 m0, s42, 0
    s_nop 0
    v_mfma_f32_16x16x32_bf16 v[168:171], v[40:43], v[72:75], v[168:171]
    buffer_load_dwordx4 v2, s[16:19], s41 offen lds
    v_mfma_f32_16x16x32_bf16 v[184:187], v[40:43], v[76:79], v[184:187]
    v_mfma_f32_16x16x32_bf16 v[140:143], v[44:47], v[64:67], v[140:143]
    v_mfma_f32_16x16x32_bf16 v[156:159], v[44:47], v[68:71], v[156:159]
    v_mfma_f32_16x16x32_bf16 v[172:175], v[44:47], v[72:75], v[172:175]
    v_mfma_f32_16x16x32_bf16 v[188:191], v[44:47], v[76:79], v[188:191]
    s_waitcnt lgkmcnt(0)
    v_mfma_f32_16x16x32_bf16 v[192:195], v[48:51], v[64:67], v[192:195]
    buffer_load_dwordx4 v[120:123], v4, s[24:27], s43 offen offset:512
    v_mfma_f32_16x16x32_bf16 v[208:211], v[48:51], v[68:71], v[208:211]
    ds_read_b64_tr_b16 v[32:33], v8 offset:4096
    v_mfma_f32_16x16x32_bf16 v[224:227], v[48:51], v[72:75], v[224:227]
    ds_read_b64_tr_b16 v[34:35], v8 offset:4608
    v_mfma_f32_16x16x32_bf16 v[240:243], v[48:51], v[76:79], v[240:243]
    ds_read_b64_tr_b16 v[36:37], v9 offset:4096
    v_mfma_f32_16x16x32_bf16 v[196:199], v[52:55], v[64:67], v[196:199]
    ds_read_b64_tr_b16 v[38:39], v9 offset:4608
    v_mfma_f32_16x16x32_bf16 v[212:215], v[52:55], v[68:71], v[212:215]
    buffer_load_dwordx4 v[124:127], v4, s[24:27], s43 offen offset:768
    v_mfma_f32_16x16x32_bf16 v[228:231], v[52:55], v[72:75], v[228:231]
    ds_read_b64_tr_b16 v[40:41], v10 offset:4096
    v_mfma_f32_16x16x32_bf16 v[244:247], v[52:55], v[76:79], v[244:247]
    ds_read_b64_tr_b16 v[42:43], v10 offset:4608
    v_mfma_f32_16x16x32_bf16 v[200:203], v[56:59], v[64:67], v[200:203]
    ds_read_b64_tr_b16 v[44:45], v11 offset:4096
    v_mfma_f32_16x16x32_bf16 v[216:219], v[56:59], v[68:71], v[216:219]
    ds_read_b64_tr_b16 v[46:47], v11 offset:4608
    s_add_u32 m0, s42, 1024
    s_add_u32 s43, s43, 133120
    v_mfma_f32_16x16x32_bf16 v[232:235], v[56:59], v[72:75], v[232:235]
    buffer_load_dwordx4 v3, s[16:19], s41 offen lds
    v_mfma_f32_16x16x32_bf16 v[248:251], v[56:59], v[76:79], v[248:251]
    v_mfma_f32_16x16x32_bf16 v[204:207], v[60:63], v[64:67], v[204:207]
    v_mfma_f32_16x16x32_bf16 v[220:223], v[60:63], v[68:71], v[220:223]
    v_mfma_f32_16x16x32_bf16 v[236:239], v[60:63], v[72:75], v[236:239]
    v_mfma_f32_16x16x32_bf16 v[252:255], v[60:63], v[76:79], v[252:255]
    s_waitcnt vmcnt(13) lgkmcnt(0)
    v_mfma_f32_16x16x32_bf16 v[128:131], v[32:35], v[80:83], v[128:131]
    buffer_load_dwordx4 v[64:67], v4, s[24:27], s43 offen offset:0
    v_mfma_f32_16x16x32_bf16 v[144:147], v[32:35], v[84:87], v[144:147]
    ds_read_b64_tr_b16 v[48:49], v8 offset:12288
    v_mfma_f32_16x16x32_bf16 v[160:163], v[32:35], v[88:91], v[160:163]
    ds_read_b64_tr_b16 v[50:51], v8 offset:12800
    v_mfma_f32_16x16x32_bf16 v[176:179], v[32:35], v[92:95], v[176:179]
    ds_read_b64_tr_b16 v[52:53], v9 offset:12288
    v_mfma_f32_16x16x32_bf16 v[132:135], v[36:39], v[80:83], v[132:135]
    ds_read_b64_tr_b16 v[54:55], v9 offset:12800
    v_mfma_f32_16x16x32_bf16 v[148:151], v[36:39], v[84:87], v[148:151]
    buffer_load_dwordx4 v[68:71], v4, s[24:27], s43 offen offset:256
    v_mfma_f32_16x16x32_bf16 v[164:167], v[36:39], v[88:91], v[164:167]
    ds_read_b64_tr_b16 v[56:57], v10 offset:12288
    v_mfma_f32_16x16x32_bf16 v[180:183], v[36:39], v[92:95], v[180:183]
    ds_read_b64_tr_b16 v[58:59], v10 offset:12800
    v_mfma_f32_16x16x32_bf16 v[136:139], v[40:43], v[80:83], v[136:139]
    ds_read_b64_tr_b16 v[60:61], v11 offset:12288
    v_mfma_f32_16x16x32_bf16 v[152:155], v[40:43], v[84:87], v[152:155]
    ds_read_b64_tr_b16 v[62:63], v11 offset:12800
    s_add_u32 m0, s42, 8192
    s_nop 0
    v_mfma_f32_16x16x32_bf16 v[168:171], v[40:43], v[88:91], v[168:171]
    buffer_load_dwordx4 v2, s[20:23], s41 offen lds
    v_mfma_f32_16x16x32_bf16 v[184:187], v[40:43], v[92:95], v[184:187]
    v_mfma_f32_16x16x32_bf16 v[140:143], v[44:47], v[80:83], v[140:143]
    v_mfma_f32_16x16x32_bf16 v[156:159], v[44:47], v[84:87], v[156:159]
    v_mfma_f32_16x16x32_bf16 v[172:175], v[44:47], v[88:91], v[172:175]
    v_mfma_f32_16x16x32_bf16 v[188:191], v[44:47], v[92:95], v[188:191]
    s_waitcnt lgkmcnt(0)
    s_barrier
    v_mfma_f32_16x16x32_bf16 v[192:195], v[48:51], v[80:83], v[192:195]
    buffer_load_dwordx4 v[72:75], v4, s[24:27], s43 offen offset:512
    v_mfma_f32_16x16x32_bf16 v[208:211], v[48:51], v[84:87], v[208:211]
    ds_read_b64_tr_b16 v[32:33], v8 offset:16384
    v_mfma_f32_16x16x32_bf16 v[224:227], v[48:51], v[88:91], v[224:227]
    ds_read_b64_tr_b16 v[34:35], v8 offset:16896
    v_mfma_f32_16x16x32_bf16 v[240:243], v[48:51], v[92:95], v[240:243]
    ds_read_b64_tr_b16 v[36:37], v9 offset:16384
    v_mfma_f32_16x16x32_bf16 v[196:199], v[52:55], v[80:83], v[196:199]
    ds_read_b64_tr_b16 v[38:39], v9 offset:16896
    v_mfma_f32_16x16x32_bf16 v[212:215], v[52:55], v[84:87], v[212:215]
    buffer_load_dwordx4 v[76:79], v4, s[24:27], s43 offen offset:768
    v_mfma_f32_16x16x32_bf16 v[228:231], v[52:55], v[88:91], v[228:231]
    ds_read_b64_tr_b16 v[40:41], v10 offset:16384
    v_mfma_f32_16x16x32_bf16 v[244:247], v[52:55], v[92:95], v[244:247]
    ds_read_b64_tr_b16 v[42:43], v10 offset:16896
    v_mfma_f32_16x16x32_bf16 v[200:203], v[56:59], v[80:83], v[200:203]
    ds_read_b64_tr_b16 v[44:45], v11 offset:16384
    v_mfma_f32_16x16x32_bf16 v[216:219], v[56:59], v[84:87], v[216:219]
    ds_read_b64_tr_b16 v[46:47], v11 offset:16896
    s_add_u32 m0, s42, 9216
    s_add_u32 s43, s43, 133120
    v_mfma_f32_16x16x32_bf16 v[232:235], v[56:59], v[88:91], v[232:235]
    buffer_load_dwordx4 v3, s[20:23], s41 offen lds
    v_mfma_f32_16x16x32_bf16 v[248:251], v[56:59], v[92:95], v[248:251]
    s_add_u32 s41, s41, 221184
    s_add_u32 s42, s42, 0x4000
    s_and_b32 s42, s42, 0xffff
    v_mfma_f32_16x16x32_bf16 v[204:207], v[60:63], v[80:83], v[204:207]
    v_mfma_f32_16x16x32_bf16 v[220:223], v[60:63], v[84:87], v[220:223]
    v_mfma_f32_16x16x32_bf16 v[236:239], v[60:63], v[88:91], v[236:239]
    v_mfma_f32_16x16x32_bf16 v[252:255], v[60:63], v[92:95], v[252:255]
    s_waitcnt vmcnt(13) lgkmcnt(0)
    v_mfma_f32_16x16x32_bf16 v[128:131], v[32:35], v[96:99], v[128:131]
    buffer_load_dwordx4 v[80:83], v4, s[24:27], s43 offen offset:0
    v_mfma_f32_16x16x32_bf16 v[144:147], v[32:35], v[100:103], v[144:147]
    ds_read_b64_tr_b16 v[48:49], v8 offset:24576
    v_mfma_f32_16x16x32_bf16 v[160:163], v[32:35], v[104:107], v[160:163]
    ds_read_b64_tr_b16 v[50:51], v8 offset:25088
    v_mfma_f32_16x16x32_bf16 v[176:179], v[32:35], v[108:111], v[176:179]
    ds_read_b64_tr_b16 v[52:53], v9 offset:24576
    v_mfma_f32_16x16x32_bf16 v[132:135], v[36:39], v[96:99], v[132:135]
    ds_read_b64_tr_b16 v[54:55], v9 offset:25088
    v_mfma_f32_16x16x32_bf16 v[148:151], v[36:39], v[100:103], v[148:151]
    buffer_load_dwordx4 v[84:87], v4, s[24:27], s43 offen offset:256
    v_mfma_f32_16x16x32_bf16 v[164:167], v[36:39], v[104:107], v[164:167]
    ds_read_b64_tr_b16 v[56:57], v10 offset:24576
    v_mfma_f32_16x16x32_bf16 v[180:183], v[36:39], v[108:111], v[180:183]
    ds_read_b64_tr_b16 v[58:59], v10 offset:25088
    v_mfma_f32_16x16x32_bf16 v[136:139], v[40:43], v[96:99], v[136:139]
    ds_read_b64_tr_b16 v[60:61], v11 offset:24576
    v_mfma_f32_16x16x32_bf16 v[152:155], v[40:43], v[100:103], v[152:155]
    ds_read_b64_tr_b16 v[62:63], v11 offset:25088
    s_add_u32 m0, s42, 0
    s_nop 0
    v_mfma_f32_16x16x32_bf16 v[168:171], v[40:43], v[104:107], v[168:171]
    buffer_load_dwordx4 v2, s[16:19], s41 offen lds
    v_mfma_f32_16x16x32_bf16 v[184:187], v[40:43], v[108:111], v[184:187]
    v_mfma_f32_16x16x32_bf16 v[140:143], v[44:47], v[96:99], v[140:143]
    v_mfma_f32_16x16x32_bf16 v[156:159], v[44:47], v[100:103], v[156:159]
    v_mfma_f32_16x16x32_bf16 v[172:175], v[44:47], v[104:107], v[172:175]
    v_mfma_f32_16x16x32_bf16 v[188:191], v[44:47], v[108:111], v[188:191]
    s_waitcnt lgkmcnt(0)
    v_mfma_f32_16x16x32_bf16 v[192:195], v[48:51], v[96:99], v[192:195]
    buffer_load_dwordx4 v[88:91], v4, s[24:27], s43 offen offset:512
    v_mfma_f32_16x16x32_bf16 v[208:211], v[48:51], v[100:103], v[208:211]
    ds_read_b64_tr_b16 v[32:33], v8 offset:20480
    v_mfma_f32_16x16x32_bf16 v[224:227], v[48:51], v[104:107], v[224:227]
    ds_read_b64_tr_b16 v[34:35], v8 offset:20992
    v_mfma_f32_16x16x32_bf16 v[240:243], v[48:51], v[108:111], v[240:243]
    ds_read_b64_tr_b16 v[36:37], v9 offset:20480
    v_mfma_f32_16x16x32_bf16 v[196:199], v[52:55], v[96:99], v[196:199]
    ds_read_b64_tr_b16 v[38:39], v9 offset:20992
    v_mfma_f32_16x16x32_bf16 v[212:215], v[52:55], v[100:103], v[212:215]
    buffer_load_dwordx4 v[92:95], v4, s[24:27], s43 offen offset:768
    v_mfma_f32_16x16x32_bf16 v[228:231], v[52:55], v[104:107], v[228:231]
    ds_read_b64_tr_b16 v[40:41], v10 offset:20480
    v_mfma_f32_16x16x32_bf16 v[244:247], v[52:55], v[108:111], v[244:247]
    ds_read_b64_tr_b16 v[42:43], v10 offset:20992
    v_mfma_f32_16x16x32_bf16 v[200:203], v[56:59], v[96:99], v[200:203]
    ds_read_b64_tr_b16 v[44:45], v11 offset:20480
    v_mfma_f32_16x16x32_bf16 v[216:219], v[56:59], v[100:103], v[216:219]
    ds_read_b64_tr_b16 v[46:47], v11 offset:20992
    s_add_u32 m0, s42, 1024
    s_add_u32 s43, s43, 133120
    v_mfma_f32_16x16x32_bf16 v[232:235], v[56:59], v[104:107], v[232:235]
    buffer_load_dwordx4 v3, s[16:19], s41 offen lds
    v_mfma_f32_16x16x32_bf16 v[248:251], v[56:59], v[108:111], v[248:251]
    v_mfma_f32_16x16x32_bf16 v[204:207], v[60:63], v[96:99], v[204:207]
    v_mfma_f32_16x16x32_bf16 v[220:223], v[60:63], v[100:103], v[220:223]
    v_mfma_f32_16x16x32_bf16 v[236:239], v[60:63], v[104:107], v[236:239]
    v_mfma_f32_16x16x32_bf16 v[252:255], v[60:63], v[108:111], v[252:255]
    s_waitcnt vmcnt(13) lgkmcnt(0)
    v_mfma_f32_16x16x32_bf16 v[128:131], v[32:35], v[112:115], v[128:131]
    buffer_load_dwordx4 v[96:99], v4, s[24:27], s43 offen offset:0
    v_mfma_f32_16x16x32_bf16 v[144:147], v[32:35], v[116:119], v[144:147]
    ds_read_b64_tr_b16 v[48:49], v8 offset:28672
    v_mfma_f32_16x16x32_bf16 v[160:163], v[32:35], v[120:123], v[160:163]
    ds_read_b64_tr_b16 v[50:51], v8 offset:29184
    v_mfma_f32_16x16x32_bf16 v[176:179], v[32:35], v[124:127], v[176:179]
    ds_read_b64_tr_b16 v[52:53], v9 offset:28672
    v_mfma_f32_16x16x32_bf16 v[132:135], v[36:39], v[112:115], v[132:135]
    ds_read_b64_tr_b16 v[54:55], v9 offset:29184
    v_mfma_f32_16x16x32_bf16 v[148:151], v[36:39], v[116:119], v[148:151]
    buffer_load_dwordx4 v[100:103], v4, s[24:27], s43 offen offset:256
    v_mfma_f32_16x16x32_bf16 v[164:167], v[36:39], v[120:123], v[164:167]
    ds_read_b64_tr_b16 v[56:57], v10 offset:28672
    v_mfma_f32_16x16x32_bf16 v[180:183], v[36:39], v[124:127], v[180:183]
    ds_read_b64_tr_b16 v[58:59], v10 offset:29184
    v_mfma_f32_16x16x32_bf16 v[136:139], v[40:43], v[112:115], v[136:139]
    ds_read_b64_tr_b16 v[60:61], v11 offset:28672
    v_mfma_f32_16x16x32_bf16 v[152:155], v[40:43], v[116:119], v[152:155]
    ds_read_b64_tr_b16 v[62:63], v11 offset:29184
    s_add_u32 m0, s42, 8192
    s_nop 0
    v_mfma_f32_16x16x32_bf16 v[168:171], v[40:43], v[120:123], v[168:171]
    buffer_load_dwordx4 v2, s[20:23], s41 offen lds
    v_mfma_f32_16x16x32_bf16 v[184:187], v[40:43], v[124:127], v[184:187]
    v_mfma_f32_16x16x32_bf16 v[140:143], v[44:47], v[112:115], v[140:143]
    v_xor_b32 v8, 0x8000, v8
    v_xor_b32 v9, 0x8000, v9
    v_mfma_f32_16x16x32_bf16 v[156:159], v[44:47], v[116:119], v[156:159]
    v_xor_b32 v10, 0x8000, v10
    v_xor_b32 v11, 0x8000, v11
    v_mfma_f32_16x16x32_bf16 v[172:175], v[44:47], v[120:123], v[172:175]
    v_mfma_f32_16x16x32_bf16 v[188:191], v[44:47], v[124:127], v[188:191]
    s_waitcnt lgkmcnt(0)
    s_barrier
    v_mfma_f32_16x16x32_bf16 v[192:195], v[48:51], v[112:115], v[192:195]
    buffer_load_dwordx4 v[104:107], v4, s[24:27], s43 offen offset:512
    v_mfma_f32_16x16x32_bf16 v[208:211], v[48:51], v[116:119], v[208:211]
    ds_read_b64_tr_b16 v[32:33], v8 offset:0
    v_mfma_f32_16x16x32_bf16 v[224:227], v[48:51], v[120:123], v[224:227]
    ds_read_b64_tr_b16 v[34:35], v8 offset:512
    v_mfma_f32_16x16x32_bf16 v[240:243], v[48:51], v[124:127], v[240:243]
    ds_read_b64_tr_b16 v[36:37], v9 offset:0
    v_mfma_f32_16x16x32_bf16 v[196:199], v[52:55], v[112:115], v[196:199]
    ds_read_b64_tr_b16 v[38:39], v9 offset:512
    v_mfma_f32_16x16x32_bf16 v[212:215], v[52:55], v[116:119], v[212:215]
    buffer_load_dwordx4 v[108:111], v4, s[24:27], s43 offen offset:768
    v_mfma_f32_16x16x32_bf16 v[228:231], v[52:55], v[120:123], v[228:231]
    ds_read_b64_tr_b16 v[40:41], v10 offset:0
    v_mfma_f32_16x16x32_bf16 v[244:247], v[52:55], v[124:127], v[244:247]
    ds_read_b64_tr_b16 v[42:43], v10 offset:512
    v_mfma_f32_16x16x32_bf16 v[200:203], v[56:59], v[112:115], v[200:203]
    ds_read_b64_tr_b16 v[44:45], v11 offset:0
    v_mfma_f32_16x16x32_bf16 v[216:219], v[56:59], v[116:119], v[216:219]
    ds_read_b64_tr_b16 v[46:47], v11 offset:512
    s_add_u32 m0, s42, 9216
    s_add_u32 s43, s43, 133120
    v_mfma_f32_16x16x32_bf16 v[232:235], v[56:59], v[120:123], v[232:235]
    buffer_load_dwordx4 v3, s[20:23], s41 offen lds
    v_mfma_f32_16x16x32_bf16 v[248:251], v[56:59], v[124:127], v[248:251]
    s_add_u32 s41, s41, 221184
    s_add_u32 s42, s42, 0x4000
    s_and_b32 s42, s42, 0xffff
    v_mfma_f32_16x16x32_bf16 v[204:207], v[60:63], v[112:115], v[204:207]
    s_add_u32 s47, s47, -1
    s_cmp_lg_u32 s47, 0
    v_mfma_f32_16x16x32_bf16 v[220:223], v[60:63], v[116:119], v[220:223]
    v_mfma_f32_16x16x32_bf16 v[236:239], v[60:63], v[120:123], v[236:239]
    v_mfma_f32_16x16x32_bf16 v[252:255], v[60:63], v[124:127], v[252:255]
    s_cbranch_scc1 k2_loop
    v_lshlrev_b32 v2, 4, v1
    s_waitcnt vmcnt(13) lgkmcnt(0)
    v_mfma_f32_16x16x32_bf16 v[128:131], v[32:35], v[64:67], v[128:131]
    ds_read_b64_tr_b16 v[48:49], v8 offset:8192
    v_mfma_f32_16x16x32_bf16 v[144:147], v[32:35], v[68:71], v[144:147]
    buffer_load_dwordx4 v[112:115], v4, s[24:27], s43 offen offset:0
    v_mfma_f32_16x16x32_bf16 v[160:163], v[32:35], v[72:75], v[160:163]
    ds_read_b64_tr_b16 v[50:51], v8 offset:8704
    v_mfma_f32_16x16x32_bf16 v[176:179], v[32:35], v[76:79], v[176:179]
    buffer_load_dwordx4 v[116:119], v4, s[24:27], s43 offen offset:256
    v_mfma_f32_16x16x32_bf16 v[132:135], v[36:39], v[64:67], v[132:135]
    ds_read_b64_tr_b16 v[52:53], v9 offset:8192
    v_mfma_f32_16x16x32_bf16 v[148:151], v[36:39], v[68:71], v[148:151]
    buffer_load_dwordx4 v[120:123], v4, s[24:27], s43 offen offset:512
    v_mfma_f32_16x16x32_bf16 v[164:167], v[36:39], v[72:75], v[164:167]
    ds_read_b64_tr_b16 v[54:55], v9 offset:8704
    v_mfma_f32_16x16x32_bf16 v[180:183], v[36:39], v[76:79], v[180:183]
    buffer_load_dwordx4 v[124:127], v4, s[24:27], s43 offen offset:768
    v_mfma_f32_16x16x32_bf16 v[136:139], v[40:43], v[64:67], v[136:139]
    ds_read_b64_tr_b16 v[56:57], v10 offset:8192
    v_mfma_f32_16x16x32_bf16 v[152:155], v[40:43], v[68:71], v[152:155]
    ds_read_b64_tr_b16 v[58:59], v10 offset:8704
    v_mfma_f32_16x16x32_bf16 v[168:171], v[40:43], v[72:75], v[168:171]
    ds_read_b64_tr_b16 v[60:61], v11 offset:8192
    v_mfma_f32_16x16x32_bf16 v[184:187], v[40:43], v[76:79], v[184:187]
    ds_read_b64_tr_b16 v[62:63], v11 offset:8704
    v_mfma_f32_16x16x32_bf16 v[140:143], v[44:47], v[64:67], v[140:143]
    v_mfma_f32_16x16x32_bf16 v[156:159], v[44:47], v[68:71], v[156:159]
    v_mfma_f32_16x16x32_bf16 v[172:175], v[44:47], v[72:75], v[172:175]
    v_mfma_f32_16x16x32_bf16 v[188:191], v[44:47], v[76:79], v[188:191]
    s_waitcnt lgkmcnt(0)
    v_mfma_f32_16x16x32_bf16 v[192:195], v[48:51], v[64:67], v[192:195]
    ds_read_b64_tr_b16 v[32:33], v8 offset:4096
    v_mfma_f32_16x16x32_bf16 v[208:211], v[48:51], v[68:71], v[208:211]
    buffer_load_dwordx2 a[0:1], v7, s[28:31], s44 offen offset:0
    v_mfma_f32_16x16x32_bf16 v[224:227], v[48:51], v[72:75], v[224:227]
    ds_read_b64_tr_b16 v[34:35], v8 offset:4608
    v_mfma_f32_16x16x32_bf16 v[240:243], v[48:51], v[76:79], v[240:243]
    buffer_load_dwordx2 a[2:3], v7, s[28:31], s44 offen offset:128
    v_mfma_f32_16x16x32_bf16 v[196:199], v[52:55], v[64:67], v[196:199]
    ds_read_b64_tr_b16 v[36:37], v9 offset:4096
    v_mfma_f32_16x16x32_bf16 v[212:215], v[52:55], v[68:71], v[212:215]
    buffer_load_dwordx2 a[4:5], v7, s[28:31], s44 offen offset:256
    v_mfma_f32_16x16x32_bf16 v[228:231], v[52:55], v[72:75], v[228:231]
    ds_read_b64_tr_b16 v[38:39], v9 offset:4608
    v_mfma_f32_16x16x32_bf16 v[244:247], v[52:55], v[76:79], v[244:247]
    buffer_load_dwordx2 a[6:7], v7, s[28:31], s44 offen offset:384
    v_mfma_f32_16x16x32_bf16 v[200:203], v[56:59], v[64:67], v[200:203]
    ds_read_b64_tr_b16 v[40:41], v10 offset:4096
    v_mfma_f32_16x16x32_bf16 v[216:219], v[56:59], v[68:71], v[216:219]
    ds_read_b64_tr_b16 v[42:43], v10 offset:4608
    v_mfma_f32_16x16x32_bf16 v[232:235], v[56:59], v[72:75], v[232:235]
    ds_read_b64_tr_b16 v[44:45], v11 offset:4096
    v_mfma_f32_16x16x32_bf16 v[248:251], v[56:59], v[76:79], v[248:251]
    ds_read_b64_tr_b16 v[46:47], v11 offset:4608
    v_mfma_f32_16x16x32_bf16 v[204:207], v[60:63], v[64:67], v[204:207]
    v_mfma_f32_16x16x32_bf16 v[220:223], v[60:63], v[68:71], v[220:223]
    v_mfma_f32_16x16x32_bf16 v[236:239], v[60:63], v[72:75], v[236:239]
    v_mfma_f32_16x16x32_bf16 v[252:255], v[60:63], v[76:79], v[252:255]
    s_waitcnt vmcnt(15) lgkmcnt(0)
    v_mfma_f32_16x16x32_bf16 v[128:131], v[32:35], v[80:83], v[128:131]
    ds_read_b64_tr_b16 v[48:49], v8 offset:12288
    v_mfma_f32_16x16x32_bf16 v[144:147], v[32:35], v[84:87], v[144:147]
    buffer_load_dwordx2 a[8:9], v7, s[28:31], s45 offen offset:0
    v_mfma_f32_16x16x32_bf16 v[160:163], v[32:35], v[88:91], v[160:163]
    ds_read_b64_tr_b16 v[50:51], v8 offset:12800
    v_mfma_f32_16x16x32_bf16 v[176:179], v[32:35], v[92:95], v[176:179]
    buffer_load_dwordx2 a[10:11], v7, s[28:31], s45 offen offset:128
    v_mfma_f32_16x16x32_bf16 v[132:135], v[36:39], v[80:83], v[132:135]
    ds_read_b64_tr_b16 v[52:53], v9 offset:12288
    v_mfma_f32_16x16x32_bf16 v[148:151], v[36:39], v[84:87], v[148:151]
    buffer_load_dwordx2 a[12:13], v7, s[28:31], s45 offen offset:256
    v_mfma_f32_16x16x32_bf16 v[164:167], v[36:39], v[88:91], v[164:167]
    ds_read_b64_tr_b16 v[54:55], v9 offset:12800
    v_mfma_f32_16x16x32_bf16 v[180:183], v[36:39], v[92:95], v[180:183]
    buffer_load_dwordx2 a[14:15], v7, s[28:31], s45 offen offset:384
    v_mfma_f32_16x16x32_bf16 v[136:139], v[40:43], v[80:83], v[136:139]
    ds_read_b64_tr_b16 v[56:57], v10 offset:12288
    v_mfma_f32_16x16x32_bf16 v[152:155], v[40:43], v[84:87], v[152:155]
    ds_read_b64_tr_b16 v[58:59], v10 offset:12800
    v_mfma_f32_16x16x32_bf16 v[168:171], v[40:43], v[88:91], v[168:171]
    ds_read_b64_tr_b16 v[60:61], v11 offset:12288
    v_mfma_f32_16x16x32_bf16 v[184:187], v[40:43], v[92:95], v[184:187]
    ds_read_b64_tr_b16 v[62:63], v11 offset:12800
    v_mfma_f32_16x16x32_bf16 v[140:143], v[44:47], v[80:83], v[140:143]
    v_mfma_f32_16x16x32_bf16 v[156:159], v[44:47], v[84:87], v[156:159]
    v_mfma_f32_16x16x32_bf16 v[172:175], v[44:47], v[88:91], v[172:175]
    v_mfma_f32_16x16x32_bf16 v[188:191], v[44:47], v[92:95], v[188:191]
    s_waitcnt lgkmcnt(0)
    s_barrier
    v_mfma_f32_16x16x32_bf16 v[192:195], v[48:51], v[80:83], v[192:195]
    ds_read_b64_tr_b16 v[32:33], v8 offset:16384
    v_mfma_f32_16x16x32_bf16 v[208:211], v[48:51], v[84:87], v[208:211]
    buffer_load_dwordx2 v[16:17], v7, s[28:31], s46 offen offset:0 sc0 sc1
    v_mfma_f32_16x16x32_bf16 v[224:227], v[48:51], v[88:91], v[224:227]
    ds_read_b64_tr_b16 v[34:35], v8 offset:16896
    v_mfma_f32_16x16x32_bf16 v[240:243], v[48:51], v[92:95], v[240:243]
    buffer_load_dwordx2 v[18:19], v7, s[28:31], s46 offen offset:128 sc0 sc1
    v_mfma_f32_16x16x32_bf16 v[196:199], v[52:55], v[80:83], v[196:199]
    ds_read_b64_tr_b16 v[36:37], v9 offset:16384
    v_mfma_f32_16x16x32_bf16 v[212:215], v[52:55], v[84:87], v[212:215]
    buffer_load_dwordx2 v[20:21], v7, s[28:31], s46 offen offset:256 sc0 sc1
    v_mfma_f32_16x16x32_bf16 v[228:231], v[52:55], v[88:91], v[228:231]
    ds_read_b64_tr_b16 v[38:39], v9 offset:16896
    v_mfma_f32_16x16x32_bf16 v[244:247], v[52:55], v[92:95], v[244:247]
    buffer_load_dwordx2 v[22:23], v7, s[28:31], s46 offen offset:384 sc0 sc1
    v_mfma_f32_16x16x32_bf16 v[200:203], v[56:59], v[80:83], v[200:203]
    ds_read_b64_tr_b16 v[40:41], v10 offset:16384
    v_mfma_f32_16x16x32_bf16 v[216:219], v[56:59], v[84:87], v[216:219]
    ds_read_b64_tr_b16 v[42:43], v10 offset:16896
    v_mfma_f32_16x16x32_bf16 v[232:235], v[56:59], v[88:91], v[232:235]
    ds_read_b64_tr_b16 v[44:45], v11 offset:16384
    v_mfma_f32_16x16x32_bf16 v[248:251], v[56:59], v[92:95], v[248:251]
    ds_read_b64_tr_b16 v[46:47], v11 offset:16896
    v_mfma_f32_16x16x32_bf16 v[204:207], v[60:63], v[80:83], v[204:207]
    v_mfma_f32_16x16x32_bf16 v[220:223], v[60:63], v[84:87], v[220:223]
    v_mfma_f32_16x16x32_bf16 v[236:239], v[60:63], v[88:91], v[236:239]
    v_mfma_f32_16x16x32_bf16 v[252:255], v[60:63], v[92:95], v[252:255]
    s_waitcnt vmcnt(17) lgkmcnt(0)
    v_mfma_f32_16x16x32_bf16 v[128:131], v[32:35], v[96:99], v[128:131]
    ds_read_b64_tr_b16 v[48:49], v8 offset:24576
    v_mfma_f32_16x16x32_bf16 v[144:147], v[32:35], v[100:103], v[144:147]
    s_add_u32 m0, s53, 86016
    s_add_u32 s54, s53, 4096
    buffer_load_dwordx4 v2, s[48:51], s54 offen lds
    v_mfma_f32_16x16x32_bf16 v[160:163], v[32:35], v[104:107], v[160:163]
    ds_read_b64_tr_b16 v[50:51], v8 offset:25088
    v_mfma_f32_16x16x32_bf16 v[176:179], v[32:35], v[108:111], v[176:179]
    s_add_u32 m0, s53, 81920
    s_add_u32 s54, s53, 0
    buffer_load_dwordx4 v2, s[48:51], s54 offen lds
    v_mfma_f32_16x16x32_bf16 v[132:135], v[36:39], v[96:99], v[132:135]
    ds_read_b64_tr_b16 v[52:53], v9 offset:24576
    v_mfma_f32_16x16x32_bf16 v[148:151], v[36:39], v[100:103], v[148:151]
    buffer_load_dwordx4 v2, s[48:51], s54 offen offset:1024 lds
    v_mfma_f32_16x16x32_bf16 v[164:167], v[36:39], v[104:107], v[164:167]
    ds_read_b64_tr_b16 v[54:55], v9 offset:25088
    v_mfma_f32_16x16x32_bf16 v[180:183], v[36:39], v[108:111], v[180:183]
    buffer_load_dwordx4 v2, s[48:51], s54 offen offset:2048 lds
    v_mfma_f32_16x16x32_bf16 v[136:139], v[40:43], v[96:99], v[136:139]
    ds_read_b64_tr_b16 v[56:57], v10 offset:24576
    v_mfma_f32_16x16x32_bf16 v[152:155], v[40:43], v[100:103], v[152:155]
    ds_read_b64_tr_b16 v[58:59], v10 offset:25088
    v_mfma_f32_16x16x32_bf16 v[168:171], v[40:43], v[104:107], v[168:171]
    ds_read_b64_tr_b16 v[60:61], v11 offset:24576
    v_mfma_f32_16x16x32_bf16 v[184:187], v[40:43], v[108:111], v[184:187]
    ds_read_b64_tr_b16 v[62:63], v11 offset:25088
    v_mfma_f32_16x16x32_bf16 v[140:143], v[44:47], v[96:99], v[140:143]
    v_mfma_f32_16x16x32_bf16 v[156:159], v[44:47], v[100:103], v[156:159]
    v_mfma_f32_16x16x32_bf16 v[172:175], v[44:47], v[104:107], v[172:175]
    v_mfma_f32_16x16x32_bf16 v[188:191], v[44:47], v[108:111], v[188:191]
    s_waitcnt lgkmcnt(0)
    v_mfma_f32_16x16x32_bf16 v[192:195], v[48:51], v[96:99], v[192:195]
    ds_read_b64_tr_b16 v[32:33], v8 offset:20480
    v_mfma_f32_16x16x32_bf16 v[208:211], v[48:51], v[100:103], v[208:211]
    buffer_load_dwordx4 v2, s[48:51], s54 offen offset:3072 lds
    v_mfma_f32_16x16x32_bf16 v[224:227], v[48:51], v[104:107], v[224:227]
    ds_read_b64_tr_b16 v[34:35], v8 offset:20992
    v_mfma_f32_16x16x32_bf16 v[240:243], v[48:51], v[108:111], v[240:243]
    s_add_u32 m0, s53, 106496
    s_add_u32 s54, s53, 24576
    buffer_load_dwordx4 v2, s[48:51], s54 offen lds
    v_mfma_f32_16x16x32_bf16 v[196:199], v[52:55], v[96:99], v[196:199]
    ds_read_b64_tr_b16 v[36:37], v9 offset:20480
    v_mfma_f32_16x16x32_bf16 v[212:215], v[52:55], v[100:103], v[212:215]
    s_add_u32 m0, s53, 102400
    s_add_u32 s54, s53, 20480
    buffer_load_dwordx4 v2, s[48:51], s54 offen lds
    v_mfma_f32_16x16x32_bf16 v[228:231], v[52:55], v[104:107], v[228:231]
    ds_read_b64_tr_b16 v[38:39], v9 offset:20992
    v_mfma_f32_16x16x32_bf16 v[244:247], v[52:55], v[108:111], v[244:247]
    buffer_load_dwordx4 v2, s[48:51], s54 offen offset:1024 lds
    v_mfma_f32_16x16x32_bf16 v[200:203], v[56:59], v[96:99], v[200:203]
    ds_read_b64_tr_b16 v[40:41], v10 offset:20480
    v_mfma_f32_16x16x32_bf16 v[216:219], v[56:59], v[100:103], v[216:219]
    ds_read_b64_tr_b16 v[42:43], v10 offset:20992
    v_mfma_f32_16x16x32_bf16 v[232:235], v[56:59], v[104:107], v[232:235]
    ds_read_b64_tr_b16 v[44:45], v11 offset:20480
    v_mfma_f32_16x16x32_bf16 v[248:251], v[56:59], v[108:111], v[248:251]
    ds_read_b64_tr_b16 v[46:47], v11 offset:20992
    v_mfma_f32_16x16x32_bf16 v[204:207], v[60:63], v[96:99], v[204:207]
    v_mfma_f32_16x16x32_bf16 v[220:223], v[60:63], v[100:103], v[220:223]
    v_mfma_f32_16x16x32_bf16 v[236:239], v[60:63], v[104:107], v[236:239]
    v_mfma_f32_16x16x32_bf16 v[252:255], v[60:63], v[108:111], v[252:255]
    s_waitcnt vmcnt(20) lgkmcnt(0)
    v_mfma_f32_16x16x32_bf16 v[128:131], v[32:35], v[112:115], v[128:131]
    ds_read_b64_tr_b16 v[48:49], v8 offset:28672
    v_mfma_f32_16x16x32_bf16 v[144:147], v[32:35], v[116:119], v[144:147]
    buffer_load_dwordx4 v2, s[48:51], s54 offen offset:2048 lds
    v_mfma_f32_16x16x32_bf16 v[160:163], v[32:35], v[120:123], v[160:163]
    ds_read_b64_tr_b16 v[50:51], v8 offset:29184
    v_mfma_f32_16x16x32_bf16 v[176:179], v[32:35], v[124:127], v[176:179]
    buffer_load_dwordx4 v2, s[48:51], s54 offen offset:3072 lds
    v_mfma_f32_16x16x32_bf16 v[132:135], v[36:39], v[112:115], v[132:135]
    ds_read_b64_tr_b16 v[52:53], v9 offset:28672
    v_mfma_f32_16x16x32_bf16 v[148:151], v[36:39], v[116:119], v[148:151]
    s_add_u32 m0, s53, 126976
    s_add_u32 s54, s53, 45056
    buffer_load_dwordx4 v2, s[48:51], s54 offen lds
    v_mfma_f32_16x16x32_bf16 v[164:167], v[36:39], v[120:123], v[164:167]
    ds_read_b64_tr_b16 v[54:55], v9 offset:29184
    v_mfma_f32_16x16x32_bf16 v[180:183], v[36:39], v[124:127], v[180:183]
    s_add_u32 m0, s53, 122880
    s_add_u32 s54, s53, 40960
    buffer_load_dwordx4 v2, s[48:51], s54 offen lds
    v_mfma_f32_16x16x32_bf16 v[136:139], v[40:43], v[112:115], v[136:139]
    ds_read_b64_tr_b16 v[56:57], v10 offset:28672
    v_mfma_f32_16x16x32_bf16 v[152:155], v[40:43], v[116:119], v[152:155]
    ds_read_b64_tr_b16 v[58:59], v10 offset:29184
    v_mfma_f32_16x16x32_bf16 v[168:171], v[40:43], v[120:123], v[168:171]
    ds_read_b64_tr_b16 v[60:61], v11 offset:28672
    v_mfma_f32_16x16x32_bf16 v[184:187], v[40:43], v[124:127], v[184:187]
    ds_read_b64_tr_b16 v[62:63], v11 offset:29184
    v_mfma_f32_16x16x32_bf16 v[140:143], v[44:47], v[112:115], v[140:143]
    v_mfma_f32_16x16x32_bf16 v[156:159], v[44:47], v[116:119], v[156:159]
    v_mfma_f32_16x16x32_bf16 v[172:175], v[44:47], v[120:123], v[172:175]
    v_mfma_f32_16x16x32_bf16 v[188:191], v[44:47], v[124:127], v[188:191]
    s_waitcnt lgkmcnt(0)
    v_mfma_f32_16x16x32_bf16 v[192:195], v[48:51], v[112:115], v[192:195]
    buffer_load_dwordx4 v2, s[48:51], s54 offen offset:1024 lds
    v_mfma_f32_16x16x32_bf16 v[208:211], v[48:51], v[116:119], v[208:211]
    v_mfma_f32_16x16x32_bf16 v[224:227], v[48:51], v[120:123], v[224:227]
    buffer_load_dwordx4 v2, s[48:51], s54 offen offset:2048 lds
    v_mfma_f32_16x16x32_bf16 v[240:243], v[48:51], v[124:127], v[240:243]
    v_mfma_f32_16x16x32_bf16 v[196:199], v[52:55], v[112:115], v[196:199]
    buffer_load_dwordx4 v2, s[48:51], s54 offen offset:3072 lds
    v_mfma_f32_16x16x32_bf16 v[212:215], v[52:55], v[116:119], v[212:215]
    v_mfma_f32_16x16x32_bf16 v[228:231], v[52:55], v[120:123], v[228:231]
    v_mfma_f32_16x16x32_bf16 v[244:247], v[52:55], v[124:127], v[244:247]
    v_mfma_f32_16x16x32_bf16 v[200:203], v[56:59], v[112:115], v[200:203]
    v_mfma_f32_16x16x32_bf16 v[216:219], v[56:59], v[116:119], v[216:219]
    v_mfma_f32_16x16x32_bf16 v[232:235], v[56:59], v[120:123], v[232:235]
    v_mfma_f32_16x16x32_bf16 v[248:251], v[56:59], v[124:127], v[248:251]
    v_mfma_f32_16x16x32_bf16 v[204:207], v[60:63], v[112:115], v[204:207]
    v_mfma_f32_16x16x32_bf16 v[220:223], v[60:63], v[116:119], v[220:223]
    v_mfma_f32_16x16x32_bf16 v[236:239], v[60:63], v[120:123], v[236:239]
    v_mfma_f32_16x16x32_bf16 v[252:255], v[60:63], v[124:127], v[252:255]
    s_waitcnt vmcnt(15)
    s_branch k2_chk
k2_poll:
    s_waitcnt vmcnt(0)
k2_chk:
    v_max3_u32 v12, v16, v17, v18
    v_max3_u32 v13, v19, v20, v21
    v_max3_u32 v12, v12, v22, v23
    v_max_u32 v12, v12, v13
    v_cmp_eq_u32 vcc, -1, v12
    s_cbranch_vccz k2_got
    s_add_u32 s47, s47, 1
    s_bitcmp1_b32 s47, 22
    s_cbranch_scc1 k2_got
    buffer_load_dwordx2 v[16:17], v7, s[28:31], s46 offen offset:0 sc0 sc1
    buffer_load_dwordx2 v[18:19], v7, s[28:31], s46 offen offset:128 sc0 sc1
    buffer_load_dwordx2 v[20:21], v7, s[28:31], s46 offen offset:256 sc0 sc1
    buffer_load_dwordx2 v[22:23], v7, s[28:31], s46 offen offset:384 sc0 sc1
    s_branch k2_poll
k2_got:
    v_cmp_eq_u32 vcc, 0, v5
    s_mul_i32 s44, s3, 221184
    s_lshl_b32 s45, s40, 11
    s_add_u32 s44, s44, s45
    v_lshlrev_b32 v2, 4, v1
    s_waitcnt lgkmcnt(0)
    v_cndmask_b32 v64, 0, v17, vcc
    v_cndmask_b32 v65, 0, v17, vcc
    v_mov_b64 v[66:67], 0
    v_cndmask_b32 v68, 0, v19, vcc
    v_cndmask_b32 v69, 0, v19, vcc
    v_mov_b64 v[70:71], 0
    v_cndmask_b32 v72, 0, v21, vcc
    v_cndmask_b32 v73, 0, v21, vcc
    v_mov_b64 v[74:75], 0
    v_cndmask_b32 v76, 0, v23, vcc
    v_cndmask_b32 v77, 0, v23, vcc
    v_mov_b64 v[78:79], 0
    v_mfma_f32_16x16x32_bf16 v[128:131], a[0:3], v[64:67], v[128:131]
    v_mfma_f32_16x16x32_bf16 v[132:135], a[2:5], v[64:67], v[132:135]
    v_mfma_f32_16x16x32_bf16 v[192:195], a[8:11], v[64:67], v[192:195]
    v_mfma_f32_16x16x32_bf16 v[196:199], a[10:13], v[64:67], v[196:199]
    v_mul_f32 v17, v16, v16
    v_mul_f32 v16, 0xbfb8aa3b, v16
    v_rcp_f32 v17, v17
    v_mul_f32 v19, v18, v18
    v_mul_f32 v18, 0xbfb8aa3b, v18
    v_rcp_f32 v19, v19
    v_mul_f32 v21, v20, v20
    v_mul_f32 v20, 0xbfb8aa3b, v20
    v_rcp_f32 v21, v21
    v_mul_f32 v23, v22, v22
    v_mul_f32 v22, 0xbfb8aa3b, v22
    v_rcp_f32 v23, v23
    s_add_u32 m0, s53, 147456
    s_add_u32 s54, s53, 65536
    buffer_load_dwordx4 v2, s[48:51], s54 offen lds
    v_pk_mul_f32 v[32:33], v[128:129], v[16:17] op_sel_hi:[1,0]
    v_pk_mul_f32 v[34:35], v[130:131], v[16:17] op_sel_hi:[1,0]
    v_pk_mul_f32 v[36:37], v[132:133], v[16:17] op_sel_hi:[1,0]
    v_pk_mul_f32 v[38:39], v[134:135], v[16:17] op_sel_hi:[1,0]
    v_mfma_f32_16x16x32_bf16 v[136:139], a[4:7], v[64:67], v[136:139]
    v_exp_f32 v32, v32
    v_exp_f32 v33, v33
    v_mfma_f32_16x16x32_bf16 v[140:143], a[6:9], v[64:67], v[140:143]
    v_exp_f32 v34, v34
    v_exp_f32 v35, v35
    v_mfma_f32_16x16x32_bf16 v[200:203], a[12:15], v[64:67], v[200:203]
    v_exp_f32 v36, v36
    v_exp_f32 v37, v37
    v_mfma_f32_16x16x32_bf16 v[204:207], a[14:17], v[64:67], v[204:207]
    v_exp_f32 v38, v38
    v_exp_f32 v39, v39
    s_add_u32 m0, s53, 143360
    s_add_u32 s54, s53, 61440
    buffer_load_dwordx4 v2, s[48:51], s54 offen lds
    v_pk_mul_f32 v[128:129], v[128:129], v[192:193]
    v_pk_mul_f32 v[130:131], v[130:131], v[194:195]
    v_pk_mul_f32 v[132:133], v[132:133], v[196:197]
    v_pk_mul_f32 v[134:135], v[134:135], v[198:199]
    v_pk_fma_f32 v[32:33], v[32:33], v[16:17], v[16:17] op_sel:[0,1,1] op_sel_hi:[1,1,1]
    v_pk_fma_f32 v[34:35], v[34:35], v[16:17], v[16:17] op_sel:[0,1,1] op_sel_hi:[1,1,1]
    v_pk_fma_f32 v[36:37], v[36:37], v[16:17], v[16:17] op_sel:[0,1,1] op_sel_hi:[1,1,1]
    v_pk_fma_f32 v[38:39], v[38:39], v[16:17], v[16:17] op_sel:[0,1,1] op_sel_hi:[1,1,1]
    buffer_load_dwordx4 v2, s[48:51], s54 offen offset:1024 lds
    v_rcp_f32 v32, v32
    v_rcp_f32 v33, v33
    v_rcp_f32 v34, v34
    v_rcp_f32 v35, v35
    v_rcp_f32 v36, v36
    v_rcp_f32 v37, v37
    v_rcp_f32 v38, v38
    v_rcp_f32 v39, v39
    v_pk_mul_f32 v[128:129], v[128:129], v[32:33]
    v_pk_mul_f32 v[130:131], v[130:131], v[34:35]
    v_pk_mul_f32 v[132:133], v[132:133], v[36:37]
    v_pk_mul_f32 v[134:135], v[134:135], v[38:39]
    v_cvt_pk_bf16_f32 v80, v128, v129
    v_cvt_pk_bf16_f32 v81, v130, v131
    v_cvt_pk_bf16_f32 v82, v132, v133
    v_cvt_pk_bf16_f32 v83, v134, v135
    buffer_store_dwordx4 v[80:83], v2, s[32:35], s44 offen offset:0 sc1
    buffer_load_dwordx4 v2, s[48:51], s54 offen offset:2048 lds
    v_pk_mul_f32 v[40:41], v[136:137], v[16:17] op_sel_hi:[1,0]
    v_pk_mul_f32 v[42:43], v[138:139], v[16:17] op_sel_hi:[1,0]
    v_pk_mul_f32 v[44:45], v[140:141], v[16:17] op_sel_hi:[1,0]
    v_pk_mul_f32 v[46:47], v[142:143], v[16:17] op_sel_hi:[1,0]
    v_mfma_f32_16x16x32_bf16 v[144:147], a[0:3], v[68:71], v[144:147]
    v_exp_f32 v40, v40
    v_exp_f32 v41, v41
    v_mfma_f32_16x16x32_bf16 v[148:151], a[2:5], v[68:71], v[148:151]
    v_exp_f32 v42, v42
    v_exp_f32 v43, v43
    v_mfma_f32_16x16x32_bf16 v[208:211], a[8:11], v[68:71], v[208:211]
    v_exp_f32 v44, v44
    v_exp_f32 v45, v45
    v_mfma_f32_16x16x32_bf16 v[212:215], a[10:13], v[68:71], v[212:215]
    v_exp_f32 v46, v46
    v_exp_f32 v47, v47
    buffer_load_dwordx4 v2, s[48:51], s54 offen offset:3072 lds
    v_pk_mul_f32 v[136:137], v[136:137], v[200:201]
    v_pk_mul_f32 v[138:139], v[138:139], v[202:203]
    v_pk_mul_f32 v[140:141], v[140:141], v[204:205]
    v_pk_mul_f32 v[142:143], v[142:143], v[206:207]
    v_pk_fma_f32 v[40:41], v[40:41], v[16:17], v[16:17] op_sel:[0,1,1] op_sel_hi:[1,1,1]
    v_pk_fma_f32 v[42:43], v[42:43], v[16:17], v[16:17] op_sel:[0,1,1] op_sel_hi:[1,1,1]
    v_pk_fma_f32 v[44:45], v[44:45], v[16:17], v[16:17] op_sel:[0,1,1] op_sel_hi:[1,1,1]
    v_pk_fma_f32 v[46:47], v[46:47], v[16:17], v[16:17] op_sel:[0,1,1] op_sel_hi:[1,1,1]
    v_rcp_f32 v40, v40
    v_rcp_f32 v41, v41
    v_rcp_f32 v42, v42
    v_rcp_f32 v43, v43
    v_rcp_f32 v44, v44
    v_rcp_f32 v45, v45
    v_rcp_f32 v46, v46
    v_rcp_f32 v47, v47
    v_pk_mul_f32 v[136:137], v[136:137], v[40:41]
    v_pk_mul_f32 v[138:139], v[138:139], v[42:43]
    v_pk_mul_f32 v[140:141], v[140:141], v[44:45]
    v_pk_mul_f32 v[142:143], v[142:143], v[46:47]
    v_cvt_pk_bf16_f32 v84, v136, v137
    v_cvt_pk_bf16_f32 v85, v138, v139
    v_cvt_pk_bf16_f32 v86, v140, v141
    v_cvt_pk_bf16_f32 v87, v142, v143
    buffer_store_dwordx4 v[84:87], v2, s[32:35], s44 offen offset:1024 sc1
    s_add_u32 s44, s44, 55296
    v_pk_mul_f32 v[32:33], v[144:145], v[18:19] op_sel_hi:[1,0]
    v_pk_mul_f32 v[34:35], v[146:147], v[18:19] op_sel_hi:[1,0]
    v_pk_mul_f32 v[36:37], v[148:149], v[18:19] op_sel_hi:[1,0]
    v_pk_mul_f32 v[38:39], v[150:151], v[18:19] op_sel_hi:[1,0]
    v_mfma_f32_16x16x32_bf16 v[152:155], a[4:7], v[68:71], v[152:155]
    v_exp_f32 v32, v32
    v_exp_f32 v33, v33
    v_mfma_f32_16x16x32_bf16 v[156:159], a[6:9], v[68:71], v[156:159]
    v_exp_f32 v34, v34
    v_exp_f32 v35, v35
    v_mfma_f32_16x16x32_bf16 v[216:219], a[12:15], v[68:71], v[216:219]
    v_exp_f32 v36, v36
    v_exp_f32 v37, v37
    v_mfma_f32_16x16x32_bf16 v[220:223], a[14:17], v[68:71], v[220:223]
    v_exp_f32 v38, v38
    v_exp_f32 v39, v39
    v_pk_mul_f32 v[144:145], v[144:145], v[208:209]
    v_pk_mul_f32 v[146:147], v[146:147], v[210:211]
    v_pk_mul_f32 v[148:149], v[148:149], v[212:213]
    v_pk_mul_f32 v[150:151], v[150:151], v[214:215]
    v_pk_fma_f32 v[32:33], v[32:33], v[18:19], v[18:19] op_sel:[0,1,1] op_sel_hi:[1,1,1]
    v_pk_fma_f32 v[34:35], v[34:35], v[18:19], v[18:19] op_sel:[0,1,1] op_sel_hi:[1,1,1]
    v_pk_fma_f32 v[36:37], v[36:37], v[18:19], v[18:19] op_sel:[0,1,1] op_sel_hi:[1,1,1]
    v_pk_fma_f32 v[38:39], v[38:39], v[18:19], v[18:19] op_sel:[0,1,1] op_sel_hi:[1,1,1]
    v_rcp_f32 v32, v32
    v_rcp_f32 v33, v33
    v_rcp_f32 v34, v34
    v_rcp_f32 v35, v35
    v_rcp_f32 v36, v36
    v_rcp_f32 v37, v37
    v_rcp_f32 v38, v38
    v_rcp_f32 v39, v39
    v_pk_mul_f32 v[144:145], v[144:145], v[32:33]
    v_pk_mul_f32 v[146:147], v[146:147], v[34:35]
    v_pk_mul_f32 v[148:149], v[148:149], v[36:37]
    v_pk_mul_f32 v[150:151], v[150:151], v[38:39]
    v_cvt_pk_bf16_f32 v88, v144, v145
    v_cvt_pk_bf16_f32 v89, v146, v147
    v_cvt_pk_bf16_f32 v90, v148, v149
    v_cvt_pk_bf16_f32 v91, v150, v151
    buffer_store_dwordx4 v[88:91], v2, s[32:35], s44 offen offset:0 sc1
    v_pk_mul_f32 v[40:41], v[152:153], v[18:19] op_sel_hi:[1,0]
    v_pk_mul_f32 v[42:43], v[154:155], v[18:19] op_sel_hi:[1,0]
    v_pk_mul_f32 v[44:45], v[156:157], v[18:19] op_sel_hi:[1,0]
    v_pk_mul_f32 v[46:47], v[158:159], v[18:19] op_sel_hi:[1,0]
    v_mfma_f32_16x16x32_bf16 v[160:163], a[0:3], v[72:75], v[160:163]
    v_exp_f32 v40, v40
    v_exp_f32 v41, v41
    v_mfma_f32_16x16x32_bf16 v[164:167], a[2:5], v[72:75], v[164:167]
    v_exp_f32 v42, v42
    v_exp_f32 v43, v43
    v_mfma_f32_16x16x32_bf16 v[224:227], a[8:11], v[72:75], v[224:227]
    v_exp_f32 v44, v44
    v_exp_f32 v45, v45
    v_mfma_f32_16x16x32_bf16 v[228:231], a[10:13], v[72:75], v[228:231]
    v_exp_f32 v46, v46
    v_exp_f32 v47, v47
    v_pk_mul_f32 v[152:153], v[152:153], v[216:217]
    v_pk_mul_f32 v[154:155], v[154:155], v[218:219]
    v_pk_mul_f32 v[156:157], v[156:157], v[220:221]
    v_pk_mul_f32 v[158:159], v[158:159], v[222:223]
    v_pk_fma_f32 v[40:41], v[40:41], v[18:19], v[18:19] op_sel:[0,1,1] op_sel_hi:[1,1,1]
    v_pk_fma_f32 v[42:43], v[42:43], v[18:19], v[18:19] op_sel:[0,1,1] op_sel_hi:[1,1,1]
    v_pk_fma_f32 v[44:45], v[44:45], v[18:19], v[18:19] op_sel:[0,1,1] op_sel_hi:[1,1,1]
    v_pk_fma_f32 v[46:47], v[46:47], v[18:19], v[18:19] op_sel:[0,1,1] op_sel_hi:[1,1,1]
    v_rcp_f32 v40, v40
    v_rcp_f32 v41, v41
    v_rcp_f32 v42, v42
    v_rcp_f32 v43, v43
    v_rcp_f32 v44, v44
    v_rcp_f32 v45, v45
    v_rcp_f32 v46, v46
    v_rcp_f32 v47, v47
    v_pk_mul_f32 v[152:153], v[152:153], v[40:41]
    v_pk_mul_f32 v[154:155], v[154:155], v[42:43]
    v_pk_mul_f32 v[156:157], v[156:157], v[44:45]
    v_pk_mul_f32 v[158:159], v[158:159], v[46:47]
    v_cvt_pk_bf16_f32 v92, v152, v153
    v_cvt_pk_bf16_f32 v93, v154, v155
    v_cvt_pk_bf16_f32 v94, v156, v157
    v_cvt_pk_bf16_f32 v95, v158, v159
    buffer_store_dwordx4 v[92:95], v2, s[32:35], s44 offen offset:1024 sc1
    s_add_u32 s44, s44, 55296
    v_pk_mul_f32 v[32:33], v[160:161], v[20:21] op_sel_hi:[1,0]
    v_pk_mul_f32 v[34:35], v[162:163], v[20:21] op_sel_hi:[1,0]
    v_pk_mul_f32 v[36:37], v[164:165], v[20:21] op_sel_hi:[1,0]
    v_pk_mul_f32 v[38:39], v[166:167], v[20:21] op_sel_hi:[1,0]
    v_mfma_f32_16x16x32_bf16 v[168:171], a[4:7], v[72:75], v[168:171]
    v_exp_f32 v32, v32
    v_exp_f32 v33, v33
    v_mfma_f32_16x16x32_bf16 v[172:175], a[6:9], v[72:75], v[172:175]
    v_exp_f32 v34, v34
    v_exp_f32 v35, v35
    v_mfma_f32_16x16x32_bf16 v[232:235], a[12:15], v[72:75], v[232:235]
    v_exp_f32 v36, v36
    v_exp_f32 v37, v37
    v_mfma_f32_16x16x32_bf16 v[236:239], a[14:17], v[72:75], v[236:239]
    v_exp_f32 v38, v38
    v_exp_f32 v39, v39
    v_pk_mul_f32 v[160:161], v[160:161], v[224:225]
    v_pk_mul_f32 v[162:163], v[162:163], v[226:227]
    v_pk_mul_f32 v[164:165], v[164:165], v[228:229]
    v_pk_mul_f32 v[166:167], v[166:167], v[230:231]
    v_pk_fma_f32 v[32:33], v[32:33], v[20:21], v[20:21] op_sel:[0,1,1] op_sel_hi:[1,1,1]
    v_pk_fma_f32 v[34:35], v[34:35], v[20:21], v[20:21] op_sel:[0,1,1] op_sel_hi:[1,1,1]
    v_pk_fma_f32 v[36:37], v[36:37], v[20:21], v[20:21] op_sel:[0,1,1] op_sel_hi:[1,1,1]
    v_pk_fma_f32 v[38:39], v[38:39], v[20:21], v[20:21] op_sel:[0,1,1] op_sel_hi:[1,1,1]
    v_rcp_f32 v32, v32
    v_rcp_f32 v33, v33
    v_rcp_f32 v34, v34
    v_rcp_f32 v35, v35
    v_rcp_f32 v36, v36
    v_rcp_f32 v37, v37
    v_rcp_f32 v38, v38
    v_rcp_f32 v39, v39
    v_pk_mul_f32 v[160:161], v[160:161], v[32:33]
    v_pk_mul_f32 v[162:163], v[162:163], v[34:35]
    v_pk_mul_f32 v[164:165], v[164:165], v[36:37]
    v_pk_mul_f32 v[166:167], v[166:167], v[38:39]
    v_cvt_pk_bf16_f32 v96, v160, v161
    v_cvt_pk_bf16_f32 v97, v162, v163
    v_cvt_pk_bf16_f32 v98, v164, v165
    v_cvt_pk_bf16_f32 v99, v166, v167
    buffer_store_dwordx4 v[96:99], v2, s[32:35], s44 offen offset:0 sc1
    v_pk_mul_f32 v[40:41], v[168:169], v[20:21] op_sel_hi:[1,0]
    v_pk_mul_f32 v[42:43], v[170:171], v[20:21] op_sel_hi:[1,0]
    v_pk_mul_f32 v[44:45], v[172:173], v[20:21] op_sel_hi:[1,0]
    v_pk_mul_f32 v[46:47], v[174:175], v[20:21] op_sel_hi:[1,0]
    v_mfma_f32_16x16x32_bf16 v[176:179], a[0:3], v[76:79], v[176:179]
    v_exp_f32 v40, v40
    v_exp_f32 v41, v41
    v_mfma_f32_16x16x32_bf16 v[180:183], a[2:5], v[76:79], v[180:183]
    v_exp_f32 v42, v42
    v_exp_f32 v43, v43
    v_mfma_f32_16x16x32_bf16 v[240:243], a[8:11], v[76:79], v[240:243]
    v_exp_f32 v44, v44
    v_exp_f32 v45, v45
    v_mfma_f32_16x16x32_bf16 v[244:247], a[10:13], v[76:79], v[244:247]
    v_exp_f32 v46, v46
    v_exp_f32 v47, v47
    v_pk_mul_f32 v[168:169], v[168:169], v[232:233]
    v_pk_mul_f32 v[170:171], v[170:171], v[234:235]
    v_pk_mul_f32 v[172:173], v[172:173], v[236:237]
    v_pk_mul_f32 v[174:175], v[174:175], v[238:239]
    v_pk_fma_f32 v[40:41], v[40:41], v[20:21], v[20:21] op_sel:[0,1,1] op_sel_hi:[1,1,1]
    v_pk_fma_f32 v[42:43], v[42:43], v[20:21], v[20:21] op_sel:[0,1,1] op_sel_hi:[1,1,1]
    v_pk_fma_f32 v[44:45], v[44:45], v[20:21], v[20:21] op_sel:[0,1,1] op_sel_hi:[1,1,1]
    v_pk_fma_f32 v[46:47], v[46:47], v[20:21], v[20:21] op_sel:[0,1,1] op_sel_hi:[1,1,1]
    v_rcp_f32 v40, v40
    v_rcp_f32 v41, v41
    v_rcp_f32 v42, v42
    v_rcp_f32 v43, v43
    v_rcp_f32 v44, v44
    v_rcp_f32 v45, v45
    v_rcp_f32 v46, v46
    v_rcp_f32 v47, v47
    v_pk_mul_f32 v[168:169], v[168:169], v[40:41]
    v_pk_mul_f32 v[170:171], v[170:171], v[42:43]
    v_pk_mul_f32 v[172:173], v[172:173], v[44:45]
    v_pk_mul_f32 v[174:175], v[174:175], v[46:47]
    v_cvt_pk_bf16_f32 v100, v168, v169
    v_cvt_pk_bf16_f32 v101, v170, v171
    v_cvt_pk_bf16_f32 v102, v172, v173
    v_cvt_pk_bf16_f32 v103, v174, v175
    buffer_store_dwordx4 v[100:103], v2, s[32:35], s44 offen offset:1024 sc1
    s_add_u32 s44, s44, 55296
    v_pk_mul_f32 v[32:33], v[176:177], v[22:23] op_sel_hi:[1,0]
    v_pk_mul_f32 v[34:35], v[178:179], v[22:23] op_sel_hi:[1,0]
    v_pk_mul_f32 v[36:37], v[180:181], v[22:23] op_sel_hi:[1,0]
    v_pk_mul_f32 v[38:39], v[182:183], v[22:23] op_sel_hi:[1,0]
    v_mfma_f32_16x16x32_bf16 v[184:187], a[4:7], v[76:79], v[184:187]
    v_exp_f32 v32, v32
    v_exp_f32 v33, v33
    v_mfma_f32_16x16x32_bf16 v[188:191], a[6:9], v[76:79], v[188:191]
    v_exp_f32 v34, v34
    v_exp_f32 v35, v35
    v_mfma_f32_16x16x32_bf16 v[248:251], a[12:15], v[76:79], v[248:251]
    v_exp_f32 v36, v36
    v_exp_f32 v37, v37
    v_mfma_f32_16x16x32_bf16 v[252:255], a[14:17], v[76:79], v[252:255]
    v_exp_f32 v38, v38
    v_exp_f32 v39, v39
    v_pk_mul_f32 v[176:177], v[176:177], v[240:241]
    v_pk_mul_f32 v[178:179], v[178:179], v[242:243]
    v_pk_mul_f32 v[180:181], v[180:181], v[244:245]
    v_pk_mul_f32 v[182:183], v[182:183], v[246:247]
    v_pk_fma_f32 v[32:33], v[32:33], v[22:23], v[22:23] op_sel:[0,1,1] op_sel_hi:[1,1,1]
    v_pk_fma_f32 v[34:35], v[34:35], v[22:23], v[22:23] op_sel:[0,1,1] op_sel_hi:[1,1,1]
    v_pk_fma_f32 v[36:37], v[36:37], v[22:23], v[22:23] op_sel:[0,1,1] op_sel_hi:[1,1,1]
    v_pk_fma_f32 v[38:39], v[38:39], v[22:23], v[22:23] op_sel:[0,1,1] op_sel_hi:[1,1,1]
    v_rcp_f32 v32, v32
    v_rcp_f32 v33, v33
    v_rcp_f32 v34, v34
    v_rcp_f32 v35, v35
    v_rcp_f32 v36, v36
    v_rcp_f32 v37, v37
    v_rcp_f32 v38, v38
    v_rcp_f32 v39, v39
    v_pk_mul_f32 v[176:177], v[176:177], v[32:33]
    v_pk_mul_f32 v[178:179], v[178:179], v[34:35]
    v_pk_mul_f32 v[180:181], v[180:181], v[36:37]
    v_pk_mul_f32 v[182:183], v[182:183], v[38:39]
    v_cvt_pk_bf16_f32 v104, v176, v177
    v_cvt_pk_bf16_f32 v105, v178, v179
    v_cvt_pk_bf16_f32 v106, v180, v181
    v_cvt_pk_bf16_f32 v107, v182, v183
    buffer_store_dwordx4 v[104:107], v2, s[32:35], s44 offen offset:0 sc1
    v_pk_mul_f32 v[40:41], v[184:185], v[22:23] op_sel_hi:[1,0]
    v_pk_mul_f32 v[42:43], v[186:187], v[22:23] op_sel_hi:[1,0]
    v_pk_mul_f32 v[44:45], v[188:189], v[22:23] op_sel_hi:[1,0]
    v_pk_mul_f32 v[46:47], v[190:191], v[22:23] op_sel_hi:[1,0]
    v_exp_f32 v40, v40
    v_exp_f32 v41, v41
    v_exp_f32 v42, v42
    v_exp_f32 v43, v43
    v_exp_f32 v44, v44
    v_exp_f32 v45, v45
    v_exp_f32 v46, v46
    v_exp_f32 v47, v47
    v_pk_mul_f32 v[184:185], v[184:185], v[248:249]
    v_pk_mul_f32 v[186:187], v[186:187], v[250:251]
    v_pk_mul_f32 v[188:189], v[188:189], v[252:253]
    v_pk_mul_f32 v[190:191], v[190:191], v[254:255]
    v_pk_fma_f32 v[40:41], v[40:41], v[22:23], v[22:23] op_sel:[0,1,1] op_sel_hi:[1,1,1]
    v_pk_fma_f32 v[42:43], v[42:43], v[22:23], v[22:23] op_sel:[0,1,1] op_sel_hi:[1,1,1]
    v_pk_fma_f32 v[44:45], v[44:45], v[22:23], v[22:23] op_sel:[0,1,1] op_sel_hi:[1,1,1]
    v_pk_fma_f32 v[46:47], v[46:47], v[22:23], v[22:23] op_sel:[0,1,1] op_sel_hi:[1,1,1]
    v_rcp_f32 v40, v40
    v_rcp_f32 v41, v41
    v_rcp_f32 v42, v42
    v_rcp_f32 v43, v43
    v_rcp_f32 v44, v44
    v_rcp_f32 v45, v45
    v_rcp_f32 v46, v46
    v_rcp_f32 v47, v47
    v_pk_mul_f32 v[184:185], v[184:185], v[40:41]
    v_pk_mul_f32 v[186:187], v[186:187], v[42:43]
    v_pk_mul_f32 v[188:189], v[188:189], v[44:45]
    v_pk_mul_f32 v[190:191], v[190:191], v[46:47]
    v_cvt_pk_bf16_f32 v108, v184, v185
    v_cvt_pk_bf16_f32 v109, v186, v187
    v_cvt_pk_bf16_f32 v110, v188, v189
    v_cvt_pk_bf16_f32 v111, v190, v191
    buffer_store_dwordx4 v[108:111], v2, s[32:35], s44 offen offset:1024 sc1
    s_add_u32 s44, s44, 55296
k3_join:
    s_xor_b32 s15, s59, s57
    s_and_b32 s58, s59, 0xff
    s_cselect_b32 s52, 0, 4
    s_cmp_lt_u32 s15, 8192
    s_cselect_b32 s58, s58, -1
    s_cmp_eq_u32 s81, 0
    s_cselect_b32 s59, s59, -1
    v_lshlrev_b32 v3, 8, v1
    s_waitcnt lgkmcnt(0)
    v_mov_b32 v9, s65
    s_cmp_eq_u32 s59, -1
    s_waitcnt vmcnt(0)
    s_barrier
    s_cbranch_scc1 k3_nof
    s_mov_b32 exec_hi, 0
    buffer_store_dword v9, v3, s[60:63], s59 offen sc0 sc1
    s_mov_b32 exec_hi, -1
k3_nof:
    s_mov_b32 s45, s55
    s_mul_i32 s45, s45, 55296
    s_add_u32 s45, s45, 8388608
    s_add_u32 s24, s12, s45
    s_addc_u32 s25, s13, 0
    v_lshrrev_b32 v6, 5, v1
    v_mul_u32_u24 v6, 33280, v6
    v_and_b32 v7, 15, v1
    v_lshl_add_u32 v6, v7, 4, v6
    v_bfe_u32 v8, v1, 4, 1
    v_lshl_add_u32 v6, v8, 3, v6
    s_mul_i32 s46, s56, 332800
    s_lshl_b32 s15, s55, 8
    s_add_u32 s46, s46, s15
    s_mov_b32 s26, 0xd800
    s_mov_b32 s27, 0x20000
    s_add_u32 s28, s12, 0x520000
    s_addc_u32 s29, s13, 0
    s_mov_b32 s30, 0x28a000
    s_mov_b32 s31, 0x20000
    s_mov_b32 s20, s8
    s_mov_b32 s21, s9
    s_mov_b32 s22, 0x280000
    s_mov_b32 s23, 0x20000
    buffer_load_dwordx2 v[10:11], v6, s[28:31], s46 offen
    s_add_u32 s46, s46, 66560
    buffer_load_dwordx2 v[12:13], v6, s[28:31], s46 offen
    s_add_u32 s46, s46, 66560
    buffer_load_dwordx2 v[14:15], v6, s[28:31], s46 offen
    s_add_u32 s46, s46, 66560
    buffer_load_dwordx2 v[16:17], v6, s[28:31], s46 offen
    s_add_u32 s46, s46, 66560
    buffer_load_dwordx2 v[18:19], v6, s[28:31], s46 offen
    s_add_u32 s46, s46, 66560
    v_lshrrev_b32 v4, 2, v1
    v_mul_u32_u24 v4, 160, v4
    v_and_b32 v5, 3, v1
    v_lshl_add_u32 v4, v5, 3, v4
    v_mov_b32 v4, v2
    v_add_u32 v5, 81920, v4
    v_min_u32 v3, 26, v1
    v_lshlrev_b32 v3, 2, v3
    v_cmp_eq_u32 vcc, s58, v3
    v_mov_b32 v20, s52
    s_mov_b32 s36, 0xffff0000
    v_cndmask_b32 v3, v3, v20, vcc
    s_mov_b32 s37, 0
    ds_read_b128 v[40:43], v5 offset:0
    ds_read_b128 v[44:47], v5 offset:1024
    ds_read_b128 v[48:51], v5 offset:2048
    ds_read_b128 v[52:55], v5 offset:3072
    ds_read_b128 v[56:59], v5 offset:4096
    ds_read_b128 v[60:63], v5 offset:5120
    ds_read_b128 v[64:67], v5 offset:6144
    ds_read_b128 v[68:71], v5 offset:7168
    ds_read_b128 v[72:75], v5 offset:8192
    ds_read_b128 v[76:79], v5 offset:9216
    ds_read_b128 v[80:83], v5 offset:10240
    ds_read_b128 v[84:87], v5 offset:11264
    ds_read_b128 v[88:91], v5 offset:12288
    ds_read_b128 v[92:95], v5 offset:13312
    ds_read_b128 v[96:99], v5 offset:14336
    ds_read_b128 v[100:103], v5 offset:15360
    ds_read_b128 v[104:107], v5 offset:16384
    ds_read_b128 v[108:111], v5 offset:17408
    ds_read_b128 v[112:115], v5 offset:18432
    ds_read_b128 v[116:119], v5 offset:19456
    s_cmp_eq_u32 s81, 0
    s_cbranch_scc1 k3_w0
    s_sub_u32 s15, s81, 1
    s_mul_i32 s15, s15, 34816
    s_min_u32 s15, s15, 67584
    s_add_u32 m0, s15, 0
    s_add_u32 s54, s15, 81920
    buffer_load_dwordx4 v2, s[48:51], s54 offen offset:0 lds
    buffer_load_dwordx4 v2, s[48:51], s54 offen offset:1024 lds
    buffer_load_dwordx4 v2, s[48:51], s54 offen offset:2048 lds
    buffer_load_dwordx4 v2, s[48:51], s54 offen offset:3072 lds
    s_add_u32 m0, s15, 4096
    s_add_u32 s54, s15, 86016
    buffer_load_dwordx4 v2, s[48:51], s54 offen offset:0 lds
    buffer_load_dwordx4 v2, s[48:51], s54 offen offset:1024 lds
    buffer_load_dwordx4 v2, s[48:51], s54 offen offset:2048 lds
    buffer_load_dwordx4 v2, s[48:51], s54 offen offset:3072 lds
    s_waitcnt lgkmcnt(0)
    s_barrier
    s_add_u32 m0, s15, 8192
    s_add_u32 s54, s15, 90112
    buffer_load_dwordx4 v2, s[48:51], s54 offen offset:0 lds
    buffer_load_dwordx4 v2, s[48:51], s54 offen offset:1024 lds
    buffer_load_dwordx4 v2, s[48:51], s54 offen offset:2048 lds
    buffer_load_dwordx4 v2, s[48:51], s54 offen offset:3072 lds
    s_add_u32 m0, s15, 12288
    s_add_u32 s54, s15, 94208
    buffer_load_dwordx4 v2, s[48:51], s54 offen offset:0 lds
    buffer_load_dwordx4 v2, s[48:51], s54 offen offset:1024 lds
    buffer_load_dwordx4 v2, s[48:51], s54 offen offset:2048 lds
    buffer_load_dwordx4 v2, s[48:51], s54 offen offset:3072 lds
    s_add_u32 m0, s15, 16384
    s_add_u32 s54, s15, 98304
    buffer_load_dwordx4 v2, s[48:51], s54 offen offset:0 lds
    buffer_load_dwordx4 v2, s[48:51], s54 offen offset:1024 lds
    buffer_load_dwordx4 v2, s[48:51], s54 offen offset:2048 lds
    buffer_load_dwordx4 v2, s[48:51], s54 offen offset:3072 lds
    s_add_u32 m0, s15, 20480
    s_add_u32 s54, s15, 102400
    buffer_load_dwordx4 v2, s[48:51], s54 offen offset:0 lds
    buffer_load_dwordx4 v2, s[48:51], s54 offen offset:1024 lds
    buffer_load_dwordx4 v2, s[48:51], s54 offen offset:2048 lds
    buffer_load_dwordx4 v2, s[48:51], s54 offen offset:3072 lds
    s_add_u32 m0, s15, 24576
    s_add_u32 s54, s15, 106496
    buffer_load_dwordx4 v2, s[48:51], s54 offen offset:0 lds
    buffer_load_dwordx4 v2, s[48:51], s54 offen offset:1024 lds
    buffer_load_dwordx4 v2, s[48:51], s54 offen offset:2048 lds
    buffer_load_dwordx4 v2, s[48:51], s54 offen offset:3072 lds
    s_add_u32 m0, s15, 28672
    s_add_u32 s54, s15, 110592
    buffer_load_dwordx4 v2, s[48:51], s54 offen offset:0 lds
    buffer_load_dwordx4 v2, s[48:51], s54 offen offset:1024 lds
    buffer_load_dwordx4 v2, s[48:51], s54 offen offset:2048 lds
    buffer_load_dwordx4 v2, s[48:51], s54 offen offset:3072 lds
    s_add_u32 m0, s15, 32768
    s_add_u32 s54, s15, 114688
    buffer_load_dwordx4 v2, s[48:51], s54 offen offset:0 lds
    buffer_load_dwordx4 v2, s[48:51], s54 offen offset:1024 lds
    s_waitcnt vmcnt(34)
    s_branch k3_w1
k3_w0:
    s_waitcnt lgkmcnt(0)
    s_barrier
    s_waitcnt vmcnt(0)
k3_w1:
    v_lshlrev_b32 v20, 16, v10
    v_and_b32 v21, s36, v10
    v_lshlrev_b32 v22, 16, v11
    v_and_b32 v23, s36, v11
    v_lshlrev_b32 v24, 16, v12
    v_and_b32 v25, s36, v12
    v_lshlrev_b32 v26, 16, v13
    v_and_b32 v27, s36, v13
    v_lshlrev_b32 v28, 16, v14
    v_and_b32 v29, s36, v14
    v_lshlrev_b32 v30, 16, v15
    v_and_b32 v31, s36, v15
    v_lshlrev_b32 v32, 16, v16
    v_and_b32 v33, s36, v16
    v_lshlrev_b32 v34, 16, v17
    v_and_b32 v35, s36, v17
    v_lshlrev_b32 v36, 16, v18
    v_and_b32 v37, s36, v18
    v_lshlrev_b32 v38, 16, v19
    v_and_b32 v39, s36, v19
    s_cmp_lg_u32 s81, 0
    s_cbranch_scc1 k3_got
k3_poll:
    buffer_load_dword v6, v3, s[60:63], s57 offen sc0 sc1
    s_add_u32 s37, s37, 1
    s_bitcmp1_b32 s37, 20
    s_cbranch_scc1 k3_got
    s_waitcnt vmcnt(0)
    v_cmp_ne_u32 vcc, v6, v9
    s_cbranch_vccnz k3_poll
k3_got:
    s_barrier
    s_mov_b32 s43, 0
    buffer_load_dwordx4 v[120:123], v2, s[24:27], s43 offen offset:0 sc1
    buffer_load_dwordx4 v[124:127], v2, s[24:27], s43 offen offset:1024 sc1
    buffer_load_dwordx4 v[128:131], v2, s[24:27], s43 offen offset:2048 sc1
    buffer_load_dwordx4 v[132:135], v2, s[24:27], s43 offen offset:3072 sc1
    s_mov_b32 s43, 4096
    buffer_load_dwordx4 v[136:139], v2, s[24:27], s43 offen offset:0 sc1
    buffer_load_dwordx4 v[140:143], v2, s[24:27], s43 offen offset:1024 sc1
    buffer_load_dwordx4 v[144:147], v2, s[24:27], s43 offen offset:2048 sc1
    buffer_load_dwordx4 v[148:151], v2, s[24:27], s43 offen offset:3072 sc1
    s_mov_b32 s43, 8192
    buffer_load_dwordx4 v[152:155], v2, s[24:27], s43 offen offset:0 sc1
    buffer_load_dwordx4 v[156:159], v2, s[24:27], s43 offen offset:1024 sc1
    buffer_load_dwordx4 v[160:163], v2, s[24:27], s43 offen offset:2048 sc1
    s_waitcnt vmcnt(10) lgkmcnt(5)
    v_mfma_f32_16x16x32_bf16 v[20:23], v[40:43], v[120:123], v[20:23]
    buffer_load_dwordx4 v[164:167], v2, s[24:27], s43 offen offset:3072 sc1
    v_mfma_f32_16x16x32_bf16 v[24:27], v[44:47], v[120:123], v[24:27]
    v_mfma_f32_16x16x32_bf16 v[28:31], v[48:51], v[120:123], v[28:31]
    v_mfma_f32_16x16x32_bf16 v[32:35], v[52:55], v[120:123], v[32:35]
    v_mfma_f32_16x16x32_bf16 v[36:39], v[56:59], v[120:123], v[36:39]
    s_waitcnt vmcnt(10) lgkmcnt(5)
    v_mfma_f32_16x16x32_bf16 v[20:23], v[60:63], v[124:127], v[20:23]
    s_mov_b32 s43, 12288
    buffer_load_dwordx4 v[120:123], v2, s[24:27], s43 offen offset:0 sc1
    v_mfma_f32_16x16x32_bf16 v[24:27], v[64:67], v[124:127], v[24:27]
    v_mfma_f32_16x16x32_bf16 v[28:31], v[68:71], v[124:127], v[28:31]
    v_mfma_f32_16x16x32_bf16 v[32:35], v[72:75], v[124:127], v[32:35]
    v_mfma_f32_16x16x32_bf16 v[36:39], v[76:79], v[124:127], v[36:39]
    s_waitcnt vmcnt(10) lgkmcnt(5)
    s_barrier
    v_add_u32 v5, 102400, v4
    v_mfma_f32_16x16x32_bf16 v[20:23], v[80:83], v[128:131], v[20:23]
    buffer_load_dwordx4 v[124:127], v2, s[24:27], s43 offen offset:1024 sc1
    ds_read_b128 v[40:43], v5 offset:0
    v_mfma_f32_16x16x32_bf16 v[24:27], v[84:87], v[128:131], v[24:27]
    ds_read_b128 v[44:47], v5 offset:1024
    v_mfma_f32_16x16x32_bf16 v[28:31], v[88:91], v[128:131], v[28:31]
    ds_read_b128 v[48:51], v5 offset:2048
    v_mfma_f32_16x16x32_bf16 v[32:35], v[92:95], v[128:131], v[32:35]
    ds_read_b128 v[52:55], v5 offset:3072
    v_mfma_f32_16x16x32_bf16 v[36:39], v[96:99], v[128:131], v[36:39]
    ds_read_b128 v[56:59], v5 offset:4096
    s_waitcnt vmcnt(10) lgkmcnt(5)
    v_mfma_f32_16x16x32_bf16 v[20:23], v[100:103], v[132:135], v[20:23]
    buffer_load_dwordx4 v[128:131], v2, s[24:27], s43 offen offset:2048 sc1
    ds_read_b128 v[60:63], v5 offset:5120
    v_mfma_f32_16x16x32_bf16 v[24:27], v[104:107], v[132:135], v[24:27]
    ds_read_b128 v[64:67], v5 offset:6144
    v_mfma_f32_16x16x32_bf16 v[28:31], v[108:111], v[132:135], v[28:31]
    ds_read_b128 v[68:71], v5 offset:7168
    v_mfma_f32_16x16x32_bf16 v[32:35], v[112:115], v[132:135], v[32:35]
    ds_read_b128 v[72:75], v5 offset:8192
    v_mfma_f32_16x16x32_bf16 v[36:39], v[116:119], v[132:135], v[36:39]
    ds_read_b128 v[76:79], v5 offset:9216
    s_waitcnt vmcnt(10) lgkmcnt(5)
    v_mfma_f32_16x16x32_bf16 v[20:23], v[40:43], v[136:139], v[20:23]
    buffer_load_dwordx4 v[132:135], v2, s[24:27], s43 offen offset:3072 sc1
    ds_read_b128 v[80:83], v5 offset:10240
    v_mfma_f32_16x16x32_bf16 v[24:27], v[44:47], v[136:139], v[24:27]
    ds_read_b128 v[84:87], v5 offset:11264
    v_mfma_f32_16x16x32_bf16 v[28:31], v[48:51], v[136:139], v[28:31]
    ds_read_b128 v[88:91], v5 offset:12288
    v_mfma_f32_16x16x32_bf16 v[32:35], v[52:55], v[136:139], v[32:35]
    ds_read_b128 v[92:95], v5 offset:13312
    v_mfma_f32_16x16x32_bf16 v[36:39], v[56:59], v[136:139], v[36:39]
    ds_read_b128 v[96:99], v5 offset:14336
    s_waitcnt vmcnt(10) lgkmcnt(5)
    v_mfma_f32_16x16x32_bf16 v[20:23], v[60:63], v[140:143], v[20:23]
    s_mov_b32 s43, 16384
    buffer_load_dwordx4 v[136:139], v2, s[24:27], s43 offen offset:0 sc1
    ds_read_b128 v[100:103], v5 offset:15360
    v_mfma_f32_16x16x32_bf16 v[24:27], v[64:67], v[140:143], v[24:27]
    ds_read_b128 v[104:107], v5 offset:16384
    v_mfma_f32_16x16x32_bf16 v[28:31], v[68:71], v[140:143], v[28:31]
    ds_read_b128 v[108:111], v5 offset:17408
    v_mfma_f32_16x16x32_bf16 v[32:35], v[72:75], v[140:143], v[32:35]
    ds_read_b128 v[112:115], v5 offset:18432
    v_mfma_f32_16x16x32_bf16 v[36:39], v[76:79], v[140:143], v[36:39]
    ds_read_b128 v[116:119], v5 offset:19456
    s_waitcnt vmcnt(10) lgkmcnt(5)
    s_barrier
    v_add_u32 v5, 122880, v4
    v_mfma_f32_16x16x32_bf16 v[20:23], v[80:83], v[144:147], v[20:23]
    buffer_load_dwordx4 v[140:143], v2, s[24:27], s43 offen offset:1024 sc1
    ds_read_b128 v[40:43], v5 offset:0
    v_mfma_f32_16x16x32_bf16 v[24:27], v[84:87], v[144:147], v[24:27]
    ds_read_b128 v[44:47], v5 offset:1024
    v_mfma_f32_16x16x32_bf16 v[28:31], v[88:91], v[144:147], v[28:31]
    ds_read_b128 v[48:51], v5 offset:2048
    v_mfma_f32_16x16x32_bf16 v[32:35], v[92:95], v[144:147], v[32:35]
    ds_read_b128 v[52:55], v5 offset:3072
    v_mfma_f32_16x16x32_bf16 v[36:39], v[96:99], v[144:147], v[36:39]
    ds_read_b128 v[56:59], v5 offset:4096
    s_waitcnt vmcnt(10) lgkmcnt(5)
    v_mfma_f32_16x16x32_bf16 v[20:23], v[100:103], v[148:151], v[20:23]
    buffer_load_dwordx4 v[144:147], v2, s[24:27], s43 offen offset:2048 sc1
    ds_read_b128 v[60:63], v5 offset:5120
    v_mfma_f32_16x16x32_bf16 v[24:27], v[104:107], v[148:151], v[24:27]
    ds_read_b128 v[64:67], v5 offset:6144
    v_mfma_f32_16x16x32_bf16 v[28:31], v[108:111], v[148:151], v[28:31]
    ds_read_b128 v[68:71], v5 offset:7168
    v_mfma_f32_16x16x32_bf16 v[32:35], v[112:115], v[148:151], v[32:35]
    ds_read_b128 v[72:75], v5 offset:8192
    v_mfma_f32_16x16x32_bf16 v[36:39], v[116:119], v[148:151], v[36:39]
    ds_read_b128 v[76:79], v5 offset:9216
    s_waitcnt vmcnt(10) lgkmcnt(5)
    v_mfma_f32_16x16x32_bf16 v[20:23], v[40:43], v[152:155], v[20:23]
    buffer_load_dwordx4 v[148:151], v2, s[24:27], s43 offen offset:3072 sc1
    ds_read_b128 v[80:83], v5 offset:10240
    v_mfma_f32_16x16x32_bf16 v[24:27], v[44:47], v[152:155], v[24:27]
    ds_read_b128 v[84:87], v5 offset:11264
    v_mfma_f32_16x16x32_bf16 v[28:31], v[48:51], v[152:155], v[28:31]
    ds_read_b128 v[88:91], v5 offset:12288
    v_mfma_f32_16x16x32_bf16 v[32:35], v[52:55], v[152:155], v[32:35]
    ds_read_b128 v[92:95], v5 offset:13312
    v_mfma_f32_16x16x32_bf16 v[36:39], v[56:59], v[152:155], v[36:39]
    ds_read_b128 v[96:99], v5 offset:14336
    s_waitcnt vmcnt(10) lgkmcnt(5)
    v_mfma_f32_16x16x32_bf16 v[20:23], v[60:63], v[156:159], v[20:23]
    s_mov_b32 s43, 20480
    buffer_load_dwordx4 v[152:155], v2, s[24:27], s43 offen offset:0 sc1
    ds_read_b128 v[100:103], v5 offset:15360
    v_mfma_f32_16x16x32_bf16 v[24:27], v[64:67], v[156:159], v[24:27]
    ds_read_b128 v[104:107], v5 offset:16384
    v_mfma_f32_16x16x32_bf16 v[28:31], v[68:71], v[156:159], v[28:31]
    ds_read_b128 v[108:111], v5 offset:17408
    v_mfma_f32_16x16x32_bf16 v[32:35], v[72:75], v[156:159], v[32:35]
    ds_read_b128 v[112:115], v5 offset:18432
    v_mfma_f32_16x16x32_bf16 v[36:39], v[76:79], v[156:159], v[36:39]
    ds_read_b128 v[116:119], v5 offset:19456
    s_waitcnt vmcnt(10) lgkmcnt(5)
    s_barrier
    v_add_u32 v5, 143360, v4
    v_mfma_f32_16x16x32_bf16 v[20:23], v[80:83], v[160:163], v[20:23]
    buffer_load_dwordx4 v[156:159], v2, s[24:27], s43 offen offset:1024 sc1
    ds_read_b128 v[40:43], v5 offset:0
    v_mfma_f32_16x16x32_bf16 v[24:27], v[84:87], v[160:163], v[24:27]
    ds_read_b128 v[44:47], v5 offset:1024
    v_mfma_f32_16x16x32_bf16 v[28:31], v[88:91], v[160:163], v[28:31]
    ds_read_b128 v[48:51], v5 offset:2048
    v_mfma_f32_16x16x32_bf16 v[32:35], v[92:95], v[160:163], v[32:35]
    ds_read_b128 v[52:55], v5 offset:3072
    v_mfma_f32_16x16x32_bf16 v[36:39], v[96:99], v[160:163], v[36:39]
    ds_read_b128 v[56:59], v5 offset:4096
    s_waitcnt vmcnt(10) lgkmcnt(5)
    v_mfma_f32_16x16x32_bf16 v[20:23], v[100:103], v[164:167], v[20:23]
    buffer_load_dwordx4 v[160:163], v2, s[24:27], s43 offen offset:2048 sc1
    ds_read_b128 v[60:63], v5 offset:5120
    v_mfma_f32_16x16x32_bf16 v[24:27], v[104:107], v[164:167], v[24:27]
    ds_read_b128 v[64:67], v5 offset:6144
    v_mfma_f32_16x16x32_bf16 v[28:31], v[108:111], v[164:167], v[28:31]
    ds_read_b128 v[68:71], v5 offset:7168
    v_mfma_f32_16x16x32_bf16 v[32:35], v[112:115], v[164:167], v[32:35]
    ds_read_b128 v[72:75], v5 offset:8192
    v_mfma_f32_16x16x32_bf16 v[36:39], v[116:119], v[164:167], v[36:39]
    ds_read_b128 v[76:79], v5 offset:9216
    s_waitcnt vmcnt(10) lgkmcnt(5)
    v_mfma_f32_16x16x32_bf16 v[20:23], v[40:43], v[120:123], v[20:23]
    buffer_load_dwordx4 v[164:167], v2, s[24:27], s43 offen offset:3072 sc1
    ds_read_b128 v[80:83], v5 offset:10240
    v_mfma_f32_16x16x32_bf16 v[24:27], v[44:47], v[120:123], v[24:27]
    ds_read_b128 v[84:87], v5 offset:11264
    v_mfma_f32_16x16x32_bf16 v[28:31], v[48:51], v[120:123], v[28:31]
    ds_read_b128 v[88:91], v5 offset:12288
    s_add_u32 m0, s53, 106496
    s_add_u32 s54, s53, 188416
    buffer_load_dwordx4 v2, s[48:51], s54 offen lds
    v_mfma_f32_16x16x32_bf16 v[32:35], v[52:55], v[120:123], v[32:35]
    ds_read_b128 v[92:95], v5 offset:13312
    v_mfma_f32_16x16x32_bf16 v[36:39], v[56:59], v[120:123], v[36:39]
    ds_read_b128 v[96:99], v5 offset:14336
    s_waitcnt vmcnt(11) lgkmcnt(5)
    v_mfma_f32_16x16x32_bf16 v[20:23], v[60:63], v[124:127], v[20:23]
    s_mov_b32 s43, 24576
    buffer_load_dwordx4 v[120:123], v2, s[24:27], s43 offen offset:0 sc1
    ds_read_b128 v[100:103], v5 offset:15360
    v_mfma_f32_16x16x32_bf16 v[24:27], v[64:67], v[124:127], v[24:27]
    ds_read_b128 v[104:107], v5 offset:16384
    v_mfma_f32_16x16x32_bf16 v[28:31], v[68:71], v[124:127], v[28:31]
    ds_read_b128 v[108:111], v5 offset:17408
    s_add_u32 m0, s53, 102400
    s_add_u32 s54, s53, 184320
    buffer_load_dwordx4 v2, s[48:51], s54 offen lds
    v_mfma_f32_16x16x32_bf16 v[32:35], v[72:75], v[124:127], v[32:35]
    ds_read_b128 v[112:115], v5 offset:18432
    v_mfma_f32_16x16x32_bf16 v[36:39], v[76:79], v[124:127], v[36:39]
    ds_read_b128 v[116:119], v5 offset:19456
    s_waitcnt vmcnt(12) lgkmcnt(5)
    s_barrier
    v_add_u32 v5, 0, v4
    v_mfma_f32_16x16x32_bf16 v[20:23], v[80:83], v[128:131], v[20:23]
    buffer_load_dwordx4 v[124:127], v2, s[24:27], s43 offen offset:1024 sc1
    ds_read_b128 v[40:43], v5 offset:0
    v_mfma_f32_16x16x32_bf16 v[24:27], v[84:87], v[128:131], v[24:27]
    ds_read_b128 v[44:47], v5 offset:1024
    v_mfma_f32_16x16x32_bf16 v[28:31], v[88:91], v[128:131], v[28:31]
    ds_read_b128 v[48:51], v5 offset:2048
    buffer_load_dwordx4 v2, s[48:51], s54 offen offset:1024 lds
    v_mfma_f32_16x16x32_bf16 v[32:35], v[92:95], v[128:131], v[32:35]
    ds_read_b128 v[52:55], v5 offset:3072
    v_mfma_f32_16x16x32_bf16 v[36:39], v[96:99], v[128:131], v[36:39]
    ds_read_b128 v[56:59], v5 offset:4096
    s_waitcnt vmcnt(13) lgkmcnt(5)
    v_mfma_f32_16x16x32_bf16 v[20:23], v[100:103], v[132:135], v[20:23]
    buffer_load_dwordx4 v[128:131], v2, s[24:27], s43 offen offset:2048 sc1
    ds_read_b128 v[60:63], v5 offset:5120
    v_mfma_f32_16x16x32_bf16 v[24:27], v[104:107], v[132:135], v[24:27]
    ds_read_b128 v[64:67], v5 offset:6144
    v_mfma_f32_16x16x32_bf16 v[28:31], v[108:111], v[132:135], v[28:31]
    ds_read_b128 v[68:71], v5 offset:7168
    buffer_load_dwordx4 v2, s[48:51], s54 offen offset:2048 lds
    v_mfma_f32_16x16x32_bf16 v[32:35], v[112:115], v[132:135], v[32:35]
    ds_read_b128 v[72:75], v5 offset:8192
    v_mfma_f32_16x16x32_bf16 v[36:39], v[116:119], v[132:135], v[36:39]
    ds_read_b128 v[76:79], v5 offset:9216
    s_waitcnt vmcnt(14) lgkmcnt(5)
    v_mfma_f32_16x16x32_bf16 v[20:23], v[40:43], v[136:139], v[20:23]
    buffer_load_dwordx4 v[132:135], v2, s[24:27], s43 offen offset:3072 sc1
    ds_read_b128 v[80:83], v5 offset:10240
    v_mfma_f32_16x16x32_bf16 v[24:27], v[44:47], v[136:139], v[24:27]
    ds_read_b128 v[84:87], v5 offset:11264
    v_mfma_f32_16x16x32_bf16 v[28:31], v[48:51], v[136:139], v[28:31]
    ds_read_b128 v[88:91], v5 offset:12288
    buffer_load_dwordx4 v2, s[48:51], s54 offen offset:3072 lds
    v_mfma_f32_16x16x32_bf16 v[32:35], v[52:55], v[136:139], v[32:35]
    ds_read_b128 v[92:95], v5 offset:13312
    v_mfma_f32_16x16x32_bf16 v[36:39], v[56:59], v[136:139], v[36:39]
    ds_read_b128 v[96:99], v5 offset:14336
    s_waitcnt vmcnt(15) lgkmcnt(5)
    v_mfma_f32_16x16x32_bf16 v[20:23], v[60:63], v[140:143], v[20:23]
    s_mov_b32 s43, 28672
    buffer_load_dwordx4 v[136:139], v2, s[24:27], s43 offen offset:0 sc1
    ds_read_b128 v[100:103], v5 offset:15360
    v_mfma_f32_16x16x32_bf16 v[24:27], v[64:67], v[140:143], v[24:27]
    ds_read_b128 v[104:107], v5 offset:16384
    v_mfma_f32_16x16x32_bf16 v[28:31], v[68:71], v[140:143], v[28:31]
    ds_read_b128 v[108:111], v5 offset:17408
    v_mfma_f32_16x16x32_bf16 v[32:35], v[72:75], v[140:143], v[32:35]
    ds_read_b128 v[112:115], v5 offset:18432
    v_mfma_f32_16x16x32_bf16 v[36:39], v[76:79], v[140:143], v[36:39]
    ds_read_b128 v[116:119], v5 offset:19456
    s_waitcnt vmcnt(15) lgkmcnt(5)
    s_barrier
    v_add_u32 v5, 20480, v4
    v_mfma_f32_16x16x32_bf16 v[20:23], v[80:83], v[144:147], v[20:23]
    buffer_load_dwordx4 v[140:143], v2, s[24:27], s43 offen offset:1024 sc1
    ds_read_b128 v[40:43], v5 offset:0
    v_mfma_f32_16x16x32_bf16 v[24:27], v[84:87], v[144:147], v[24:27]
    ds_read_b128 v[44:47], v5 offset:1024
    v_mfma_f32_16x16x32_bf16 v[28:31], v[88:91], v[144:147], v[28:31]
    ds_read_b128 v[48:51], v5 offset:2048
    s_add_u32 m0, s53, 126976
    s_add_u32 s54, s53, 208896
    buffer_load_dwordx4 v2, s[48:51], s54 offen lds
    v_mfma_f32_16x16x32_bf16 v[32:35], v[92:95], v[144:147], v[32:35]
    ds_read_b128 v[52:55], v5 offset:3072
    v_mfma_f32_16x16x32_bf16 v[36:39], v[96:99], v[144:147], v[36:39]
    ds_read_b128 v[56:59], v5 offset:4096
    s_waitcnt vmcnt(16) lgkmcnt(5)
    v_mfma_f32_16x16x32_bf16 v[20:23], v[100:103], v[148:151], v[20:23]
    buffer_load_dwordx4 v[144:147], v2, s[24:27], s43 offen offset:2048 sc1
    ds_read_b128 v[60:63], v5 offset:5120
    v_mfma_f32_16x16x32_bf16 v[24:27], v[104:107], v[148:151], v[24:27]
    ds_read_b128 v[64:67], v5 offset:6144
    v_mfma_f32_16x16x32_bf16 v[28:31], v[108:111], v[148:151], v[28:31]
    ds_read_b128 v[68:71], v5 offset:7168
    s_add_u32 m0, s53, 122880
    s_add_u32 s54, s53, 204800
    buffer_load_dwordx4 v2, s[48:51], s54 offen lds
    v_mfma_f32_16x16x32_bf16 v[32:35], v[112:115], v[148:151], v[32:35]
    ds_read_b128 v[72:75], v5 offset:8192
    v_mfma_f32_16x16x32_bf16 v[36:39], v[116:119], v[148:151], v[36:39]
    ds_read_b128 v[76:79], v5 offset:9216
    s_waitcnt vmcnt(17) lgkmcnt(5)
    v_mfma_f32_16x16x32_bf16 v[20:23], v[40:43], v[152:155], v[20:23]
    buffer_load_dwordx4 v[148:151], v2, s[24:27], s43 offen offset:3072 sc1
    ds_read_b128 v[80:83], v5 offset:10240
    v_mfma_f32_16x16x32_bf16 v[24:27], v[44:47], v[152:155], v[24:27]
    ds_read_b128 v[84:87], v5 offset:11264
    v_mfma_f32_16x16x32_bf16 v[28:31], v[48:51], v[152:155], v[28:31]
    ds_read_b128 v[88:91], v5 offset:12288
    buffer_load_dwordx4 v2, s[48:51], s54 offen offset:1024 lds
    v_mfma_f32_16x16x32_bf16 v[32:35], v[52:55], v[152:155], v[32:35]
    ds_read_b128 v[92:95], v5 offset:13312
    v_mfma_f32_16x16x32_bf16 v[36:39], v[56:59], v[152:155], v[36:39]
    ds_read_b128 v[96:99], v5 offset:14336
    s_waitcnt vmcnt(18) lgkmcnt(5)
    v_mfma_f32_16x16x32_bf16 v[20:23], v[60:63], v[156:159], v[20:23]
    s_mov_b32 s43, 32768
    buffer_load_dwordx4 v[152:155], v2, s[24:27], s43 offen offset:0 sc1
    ds_read_b128 v[100:103], v5 offset:15360
    v_mfma_f32_16x16x32_bf16 v[24:27], v[64:67], v[156:159], v[24:27]
    ds_read_b128 v[104:107], v5 offset:16384
    v_mfma_f32_16x16x32_bf16 v[28:31], v[68:71], v[156:159], v[28:31]
    ds_read_b128 v[108:111], v5 offset:17408
    buffer_load_dwordx4 v2, s[48:51], s54 offen offset:2048 lds
    v_mfma_f32_16x16x32_bf16 v[32:35], v[72:75], v[156:159], v[32:35]
    ds_read_b128 v[112:115], v5 offset:18432
    v_mfma_f32_16x16x32_bf16 v[36:39], v[76:79], v[156:159], v[36:39]
    ds_read_b128 v[116:119], v5 offset:19456
    s_waitcnt vmcnt(19) lgkmcnt(5)
    s_barrier
    v_add_u32 v5, 40960, v4
    v_mfma_f32_16x16x32_bf16 v[20:23], v[80:83], v[160:163], v[20:23]
    buffer_load_dwordx4 v[156:159], v2, s[24:27], s43 offen offset:1024 sc1
    ds_read_b128 v[40:43], v5 offset:0
    v_mfma_f32_16x16x32_bf16 v[24:27], v[84:87], v[160:163], v[24:27]
    ds_read_b128 v[44:47], v5 offset:1024
    v_mfma_f32_16x16x32_bf16 v[28:31], v[88:91], v[160:163], v[28:31]
    ds_read_b128 v[48:51], v5 offset:2048
    v_mfma_f32_16x16x32_bf16 v[32:35], v[92:95], v[160:163], v[32:35]
    ds_read_b128 v[52:55], v5 offset:3072
    v_mfma_f32_16x16x32_bf16 v[36:39], v[96:99], v[160:163], v[36:39]
    ds_read_b128 v[56:59], v5 offset:4096
    s_waitcnt vmcnt(19) lgkmcnt(5)
    v_mfma_f32_16x16x32_bf16 v[20:23], v[100:103], v[164:167], v[20:23]
    buffer_load_dwordx4 v[160:163], v2, s[24:27], s43 offen offset:2048 sc1
    ds_read_b128 v[60:63], v5 offset:5120
    v_mfma_f32_16x16x32_bf16 v[24:27], v[104:107], v[164:167], v[24:27]
    ds_read_b128 v[64:67], v5 offset:6144
    v_mfma_f32_16x16x32_bf16 v[28:31], v[108:111], v[164:167], v[28:31]
    ds_read_b128 v[68:71], v5 offset:7168
    buffer_load_dwordx4 v2, s[48:51], s54 offen offset:3072 lds
    v_mfma_f32_16x16x32_bf16 v[32:35], v[112:115], v[164:167], v[32:35]
    ds_read_b128 v[72:75], v5 offset:8192
    v_mfma_f32_16x16x32_bf16 v[36:39], v[116:119], v[164:167], v[36:39]
    ds_read_b128 v[76:79], v5 offset:9216
    s_waitcnt vmcnt(19) lgkmcnt(5)
    v_mfma_f32_16x16x32_bf16 v[20:23], v[40:43], v[120:123], v[20:23]
    buffer_load_dwordx4 v[164:167], v2, s[24:27], s43 offen offset:3072 sc1
    ds_read_b128 v[80:83], v5 offset:10240
    v_mfma_f32_16x16x32_bf16 v[24:27], v[44:47], v[120:123], v[24:27]
    ds_read_b128 v[84:87], v5 offset:11264
    v_mfma_f32_16x16x32_bf16 v[28:31], v[48:51], v[120:123], v[28:31]
    ds_read_b128 v[88:91], v5 offset:12288
    s_add_u32 m0, s53, 147456
    s_add_u32 s54, s53, 229376
    buffer_load_dwordx4 v2, s[48:51], s54 offen lds
    v_mfma_f32_16x16x32_bf16 v[32:35], v[52:55], v[120:123], v[32:35]
    ds_read_b128 v[92:95], v5 offset:13312
    v_mfma_f32_16x16x32_bf16 v[36:39], v[56:59], v[120:123], v[36:39]
    ds_read_b128 v[96:99], v5 offset:14336
    s_waitcnt vmcnt(19) lgkmcnt(5)
    v_mfma_f32_16x16x32_bf16 v[20:23], v[60:63], v[124:127], v[20:23]
    s_mov_b32 s43, 36864
    buffer_load_dwordx4 v[120:123], v2, s[24:27], s43 offen offset:0 sc1
    ds_read_b128 v[100:103], v5 offset:15360
    v_mfma_f32_16x16x32_bf16 v[24:27], v[64:67], v[124:127], v[24:27]
    ds_read_b128 v[104:107], v5 offset:16384
    v_mfma_f32_16x16x32_bf16 v[28:31], v[68:71], v[124:127], v[28:31]
    ds_read_b128 v[108:111], v5 offset:17408
    s_add_u32 m0, s53, 143360
    s_add_u32 s54, s53, 225280
    buffer_load_dwordx4 v2, s[48:51], s54 offen lds
    v_mfma_f32_16x16x32_bf16 v[32:35], v[72:75], v[124:127], v[32:35]
    ds_read_b128 v[112:115], v5 offset:18432
    v_mfma_f32_16x16x32_bf16 v[36:39], v[76:79], v[124:127], v[36:39]
    ds_read_b128 v[116:119], v5 offset:19456
    s_waitcnt vmcnt(19) lgkmcnt(5)
    s_barrier
    v_add_u32 v5, 61440, v4
    v_mfma_f32_16x16x32_bf16 v[20:23], v[80:83], v[128:131], v[20:23]
    buffer_load_dwordx4 v[124:127], v2, s[24:27], s43 offen offset:1024 sc1
    ds_read_b128 v[40:43], v5 offset:0
    v_mfma_f32_16x16x32_bf16 v[24:27], v[84:87], v[128:131], v[24:27]
    ds_read_b128 v[44:47], v5 offset:1024
    v_mfma_f32_16x16x32_bf16 v[28:31], v[88:91], v[128:131], v[28:31]
    ds_read_b128 v[48:51], v5 offset:2048
    buffer_load_dwordx4 v2, s[48:51], s54 offen offset:1024 lds
    v_mfma_f32_16x16x32_bf16 v[32:35], v[92:95], v[128:131], v[32:35]
    ds_read_b128 v[52:55], v5 offset:3072
    v_mfma_f32_16x16x32_bf16 v[36:39], v[96:99], v[128:131], v[36:39]
    ds_read_b128 v[56:59], v5 offset:4096
    s_waitcnt vmcnt(19) lgkmcnt(5)
    v_mfma_f32_16x16x32_bf16 v[20:23], v[100:103], v[132:135], v[20:23]
    buffer_load_dwordx4 v[128:131], v2, s[24:27], s43 offen offset:2048 sc1
    ds_read_b128 v[60:63], v5 offset:5120
    v_mfma_f32_16x16x32_bf16 v[24:27], v[104:107], v[132:135], v[24:27]
    ds_read_b128 v[64:67], v5 offset:6144
    v_mfma_f32_16x16x32_bf16 v[28:31], v[108:111], v[132:135], v[28:31]
    ds_read_b128 v[68:71], v5 offset:7168
    v_mfma_f32_16x16x32_bf16 v[32:35], v[112:115], v[132:135], v[32:35]
    ds_read_b128 v[72:75], v5 offset:8192
    v_mfma_f32_16x16x32_bf16 v[36:39], v[116:119], v[132:135], v[36:39]
    ds_read_b128 v[76:79], v5 offset:9216
    s_waitcnt vmcnt(18) lgkmcnt(5)
    v_mfma_f32_16x16x32_bf16 v[20:23], v[40:43], v[136:139], v[20:23]
    buffer_load_dwordx4 v[132:135], v2, s[24:27], s43 offen offset:3072 sc1
    ds_read_b128 v[80:83], v5 offset:10240
    v_mfma_f32_16x16x32_bf16 v[24:27], v[44:47], v[136:139], v[24:27]
    ds_read_b128 v[84:87], v5 offset:11264
    v_mfma_f32_16x16x32_bf16 v[28:31], v[48:51], v[136:139], v[28:31]
    ds_read_b128 v[88:91], v5 offset:12288
    buffer_load_dwordx4 v2, s[48:51], s54 offen offset:2048 lds
    v_mfma_f32_16x16x32_bf16 v[32:35], v[52:55], v[136:139], v[32:35]
    ds_read_b128 v[92:95], v5 offset:13312
    v_mfma_f32_16x16x32_bf16 v[36:39], v[56:59], v[136:139], v[36:39]
    ds_read_b128 v[96:99], v5 offset:14336
    s_waitcnt vmcnt(19) lgkmcnt(5)
    v_mfma_f32_16x16x32_bf16 v[20:23], v[60:63], v[140:143], v[20:23]
    s_mov_b32 s43, 40960
    buffer_load_dwordx4 v[136:139], v2, s[24:27], s43 offen offset:0 sc1
    ds_read_b128 v[100:103], v5 offset:15360
    v_mfma_f32_16x16x32_bf16 v[24:27], v[64:67], v[140:143], v[24:27]
    ds_read_b128 v[104:107], v5 offset:16384
    v_mfma_f32_16x16x32_bf16 v[28:31], v[68:71], v[140:143], v[28:31]
    ds_read_b128 v[108:111], v5 offset:17408
    buffer_load_dwordx4 v2, s[48:51], s54 offen offset:3072 lds
    v_mfma_f32_16x16x32_bf16 v[32:35], v[72:75], v[140:143], v[32:35]
    ds_read_b128 v[112:115], v5 offset:18432
    v_mfma_f32_16x16x32_bf16 v[36:39], v[76:79], v[140:143], v[36:39]
    ds_read_b128 v[116:119], v5 offset:19456
    s_waitcnt vmcnt(19) lgkmcnt(5)
    s_barrier
    v_add_u32 v5, 81920, v4
    v_mfma_f32_16x16x32_bf16 v[20:23], v[80:83], v[144:147], v[20:23]
    buffer_load_dwordx4 v[140:143], v2, s[24:27], s43 offen offset:1024 sc1
    ds_read_b128 v[40:43], v5 offset:0
    v_mfma_f32_16x16x32_bf16 v[24:27], v[84:87], v[144:147], v[24:27]
    ds_read_b128 v[44:47], v5 offset:1024
    v_mfma_f32_16x16x32_bf16 v[28:31], v[88:91], v[144:147], v[28:31]
    ds_read_b128 v[48:51], v5 offset:2048
    s_add_u32 m0, s53, 4096
    s_add_u32 s54, s53, 249856
    buffer_load_dwordx4 v2, s[48:51], s54 offen lds
    v_mfma_f32_16x16x32_bf16 v[32:35], v[92:95], v[144:147], v[32:35]
    ds_read_b128 v[52:55], v5 offset:3072
    v_mfma_f32_16x16x32_bf16 v[36:39], v[96:99], v[144:147], v[36:39]
    ds_read_b128 v[56:59], v5 offset:4096
    s_waitcnt vmcnt(19) lgkmcnt(5)
    v_mfma_f32_16x16x32_bf16 v[20:23], v[100:103], v[148:151], v[20:23]
    buffer_load_dwordx4 v[144:147], v2, s[24:27], s43 offen offset:2048 sc1
    ds_read_b128 v[60:63], v5 offset:5120
    v_mfma_f32_16x16x32_bf16 v[24:27], v[104:107], v[148:151], v[24:27]
    ds_read_b128 v[64:67], v5 offset:6144
    v_mfma_f32_16x16x32_bf16 v[28:31], v[108:111], v[148:151], v[28:31]
    ds_read_b128 v[68:71], v5 offset:7168
    s_add_u32 m0, s53, 0
    s_add_u32 s54, s53, 245760
    buffer_load_dwordx4 v2, s[48:51], s54 offen lds
    v_mfma_f32_16x16x32_bf16 v[32:35], v[112:115], v[148:151], v[32:35]
    ds_read_b128 v[72:75], v5 offset:8192
    v_mfma_f32_16x16x32_bf16 v[36:39], v[116:119], v[148:151], v[36:39]
    ds_read_b128 v[76:79], v5 offset:9216
    s_waitcnt vmcnt(19) lgkmcnt(5)
    v_mfma_f32_16x16x32_bf16 v[20:23], v[40:43], v[152:155], v[20:23]
    buffer_load_dwordx4 v[148:151], v2, s[24:27], s43 offen offset:3072 sc1
    ds_read_b128 v[80:83], v5 offset:10240
    v_mfma_f32_16x16x32_bf16 v[24:27], v[44:47], v[152:155], v[24:27]
    ds_read_b128 v[84:87], v5 offset:11264
    v_mfma_f32_16x16x32_bf16 v[28:31], v[48:51], v[152:155], v[28:31]
    ds_read_b128 v[88:91], v5 offset:12288
    v_mfma_f32_16x16x32_bf16 v[32:35], v[52:55], v[152:155], v[32:35]
    ds_read_b128 v[92:95], v5 offset:13312
    v_mfma_f32_16x16x32_bf16 v[36:39], v[56:59], v[152:155], v[36:39]
    ds_read_b128 v[96:99], v5 offset:14336
    s_waitcnt vmcnt(18) lgkmcnt(5)
    v_mfma_f32_16x16x32_bf16 v[20:23], v[60:63], v[156:159], v[20:23]
    s_mov_b32 s43, 45056
    buffer_load_dwordx4 v[152:155], v2, s[24:27], s43 offen offset:0 sc1
    ds_read_b128 v[100:103], v5 offset:15360
    v_mfma_f32_16x16x32_bf16 v[24:27], v[64:67], v[156:159], v[24:27]
    ds_read_b128 v[104:107], v5 offset:16384
    v_mfma_f32_16x16x32_bf16 v[28:31], v[68:71], v[156:159], v[28:31]
    ds_read_b128 v[108:111], v5 offset:17408
    buffer_load_dwordx4 v2, s[48:51], s54 offen offset:1024 lds
    v_mfma_f32_16x16x32_bf16 v[32:35], v[72:75], v[156:159], v[32:35]
    ds_read_b128 v[112:115], v5 offset:18432
    v_mfma_f32_16x16x32_bf16 v[36:39], v[76:79], v[156:159], v[36:39]
    ds_read_b128 v[116:119], v5 offset:19456
    s_waitcnt vmcnt(19) lgkmcnt(5)
    s_barrier
    v_add_u32 v5, 102400, v4
    v_mfma_f32_16x16x32_bf16 v[20:23], v[80:83], v[160:163], v[20:23]
    buffer_load_dwordx4 v[156:159], v2, s[24:27], s43 offen offset:1024 sc1
    ds_read_b128 v[40:43], v5 offset:0
    v_mfma_f32_16x16x32_bf16 v[24:27], v[84:87], v[160:163], v[24:27]
    ds_read_b128 v[44:47], v5 offset:1024
    v_mfma_f32_16x16x32_bf16 v[28:31], v[88:91], v[160:163], v[28:31]
    ds_read_b128 v[48:51], v5 offset:2048
    buffer_load_dwordx4 v2, s[48:51], s54 offen offset:2048 lds
    v_mfma_f32_16x16x32_bf16 v[32:35], v[92:95], v[160:163], v[32:35]
    ds_read_b128 v[52:55], v5 offset:3072
    v_mfma_f32_16x16x32_bf16 v[36:39], v[96:99], v[160:163], v[36:39]
    ds_read_b128 v[56:59], v5 offset:4096
    s_waitcnt vmcnt(19) lgkmcnt(5)
    v_mfma_f32_16x16x32_bf16 v[20:23], v[100:103], v[164:167], v[20:23]
    buffer_load_dwordx4 v[160:163], v2, s[24:27], s43 offen offset:2048 sc1
    ds_read_b128 v[60:63], v5 offset:5120
    v_mfma_f32_16x16x32_bf16 v[24:27], v[104:107], v[164:167], v[24:27]
    ds_read_b128 v[64:67], v5 offset:6144
    v_mfma_f32_16x16x32_bf16 v[28:31], v[108:111], v[164:167], v[28:31]
    ds_read_b128 v[68:71], v5 offset:7168
    buffer_load_dwordx4 v2, s[48:51], s54 offen offset:3072 lds
    v_mfma_f32_16x16x32_bf16 v[32:35], v[112:115], v[164:167], v[32:35]
    ds_read_b128 v[72:75], v5 offset:8192
    v_mfma_f32_16x16x32_bf16 v[36:39], v[116:119], v[164:167], v[36:39]
    ds_read_b128 v[76:79], v5 offset:9216
    s_waitcnt vmcnt(19) lgkmcnt(5)
    v_mfma_f32_16x16x32_bf16 v[20:23], v[40:43], v[120:123], v[20:23]
    buffer_load_dwordx4 v[164:167], v2, s[24:27], s43 offen offset:3072 sc1
    ds_read_b128 v[80:83], v5 offset:10240
    v_mfma_f32_16x16x32_bf16 v[24:27], v[44:47], v[120:123], v[24:27]
    ds_read_b128 v[84:87], v5 offset:11264
    v_mfma_f32_16x16x32_bf16 v[28:31], v[48:51], v[120:123], v[28:31]
    ds_read_b128 v[88:91], v5 offset:12288
    s_add_u32 m0, s53, 24576
    s_add_u32 s54, s53, 270336
    buffer_load_dwordx4 v2, s[48:51], s54 offen lds
    v_mfma_f32_16x16x32_bf16 v[32:35], v[52:55], v[120:123], v[32:35]
    ds_read_b128 v[92:95], v5 offset:13312
    v_mfma_f32_16x16x32_bf16 v[36:39], v[56:59], v[120:123], v[36:39]
    ds_read_b128 v[96:99], v5 offset:14336
    s_waitcnt vmcnt(19) lgkmcnt(5)
    v_mfma_f32_16x16x32_bf16 v[20:23], v[60:63], v[124:127], v[20:23]
    s_mov_b32 s43, 49152
    buffer_load_dwordx4 v[120:123], v2, s[24:27], s43 offen offset:0 sc1
    ds_read_b128 v[100:103], v5 offset:15360
    v_mfma_f32_16x16x32_bf16 v[24:27], v[64:67], v[124:127], v[24:27]
    ds_read_b128 v[104:107], v5 offset:16384
    v_mfma_f32_16x16x32_bf16 v[28:31], v[68:71], v[124:127], v[28:31]
    ds_read_b128 v[108:111], v5 offset:17408
    v_mfma_f32_16x16x32_bf16 v[32:35], v[72:75], v[124:127], v[32:35]
    ds_read_b128 v[112:115], v5 offset:18432
    v_mfma_f32_16x16x32_bf16 v[36:39], v[76:79], v[124:127], v[36:39]
    ds_read_b128 v[116:119], v5 offset:19456
    s_waitcnt vmcnt(18) lgkmcnt(5)
    s_barrier
    v_add_u32 v5, 122880, v4
    v_mfma_f32_16x16x32_bf16 v[20:23], v[80:83], v[128:131], v[20:23]
    buffer_load_dwordx4 v[124:127], v2, s[24:27], s43 offen offset:1024 sc1
    ds_read_b128 v[40:43], v5 offset:0
    v_mfma_f32_16x16x32_bf16 v[24:27], v[84:87], v[128:131], v[24:27]
    ds_read_b128 v[44:47], v5 offset:1024
    v_mfma_f32_16x16x32_bf16 v[28:31], v[88:91], v[128:131], v[28:31]
    ds_read_b128 v[48:51], v5 offset:2048
    s_add_u32 m0, s53, 20480
    s_add_u32 s54, s53, 266240
    buffer_load_dwordx4 v2, s[48:51], s54 offen lds
    v_mfma_f32_16x16x32_bf16 v[32:35], v[92:95], v[128:131], v[32:35]
    ds_read_b128 v[52:55], v5 offset:3072
    v_mfma_f32_16x16x32_bf16 v[36:39], v[96:99], v[128:131], v[36:39]
    ds_read_b128 v[56:59], v5 offset:4096
    s_waitcnt vmcnt(19) lgkmcnt(5)
    v_mfma_f32_16x16x32_bf16 v[20:23], v[100:103], v[132:135], v[20:23]
    buffer_load_dwordx4 v[128:131], v2, s[24:27], s43 offen offset:2048 sc1
    ds_read_b128 v[60:63], v5 offset:5120
    v_mfma_f32_16x16x32_bf16 v[24:27], v[104:107], v[132:135], v[24:27]
    ds_read_b128 v[64:67], v5 offset:6144
    v_mfma_f32_16x16x32_bf16 v[28:31], v[108:111], v[132:135], v[28:31]
    ds_read_b128 v[68:71], v5 offset:7168
    buffer_load_dwordx4 v2, s[48:51], s54 offen offset:1024 lds
    v_mfma_f32_16x16x32_bf16 v[32:35], v[112:115], v[132:135], v[32:35]
    ds_read_b128 v[72:75], v5 offset:8192
    v_mfma_f32_16x16x32_bf16 v[36:39], v[116:119], v[132:135], v[36:39]
    ds_read_b128 v[76:79], v5 offset:9216
    s_waitcnt vmcnt(19) lgkmcnt(5)
    v_mfma_f32_16x16x32_bf16 v[20:23], v[40:43], v[136:139], v[20:23]
    buffer_load_dwordx4 v[132:135], v2, s[24:27], s43 offen offset:3072 sc1
    ds_read_b128 v[80:83], v5 offset:10240
    v_mfma_f32_16x16x32_bf16 v[24:27], v[44:47], v[136:139], v[24:27]
    ds_read_b128 v[84:87], v5 offset:11264
    v_mfma_f32_16x16x32_bf16 v[28:31], v[48:51], v[136:139], v[28:31]
    ds_read_b128 v[88:91], v5 offset:12288
    buffer_load_dwordx4 v2, s[48:51], s54 offen offset:2048 lds
    v_mfma_f32_16x16x32_bf16 v[32:35], v[52:55], v[136:139], v[32:35]
    ds_read_b128 v[92:95], v5 offset:13312
    v_mfma_f32_16x16x32_bf16 v[36:39], v[56:59], v[136:139], v[36:39]
    ds_read_b128 v[96:99], v5 offset:14336
    s_waitcnt vmcnt(19) lgkmcnt(5)
    v_mfma_f32_16x16x32_bf16 v[20:23], v[60:63], v[140:143], v[20:23]
    s_mov_b32 s43, 53248
    buffer_load_dwordx4 v[136:139], v2, s[24:27], s43 offen offset:0 sc1
    ds_read_b128 v[100:103], v5 offset:15360
    v_mfma_f32_16x16x32_bf16 v[24:27], v[64:67], v[140:143], v[24:27]
    ds_read_b128 v[104:107], v5 offset:16384
    v_mfma_f32_16x16x32_bf16 v[28:31], v[68:71], v[140:143], v[28:31]
    ds_read_b128 v[108:111], v5 offset:17408
    buffer_load_dwordx4 v2, s[48:51], s54 offen offset:3072 lds
    v_mfma_f32_16x16x32_bf16 v[32:35], v[72:75], v[140:143], v[32:35]
    ds_read_b128 v[112:115], v5 offset:18432
    v_mfma_f32_16x16x32_bf16 v[36:39], v[76:79], v[140:143], v[36:39]
    ds_read_b128 v[116:119], v5 offset:19456
    s_waitcnt vmcnt(19) lgkmcnt(5)
    s_barrier
    v_add_u32 v5, 143360, v4
    v_mfma_f32_16x16x32_bf16 v[20:23], v[80:83], v[144:147], v[20:23]
    buffer_load_dwordx4 v[140:143], v2, s[24:27], s43 offen offset:1024 sc1
    ds_read_b128 v[40:43], v5 offset:0
    v_mfma_f32_16x16x32_bf16 v[24:27], v[84:87], v[144:147], v[24:27]
    ds_read_b128 v[44:47], v5 offset:1024
    v_mfma_f32_16x16x32_bf16 v[28:31], v[88:91], v[144:147], v[28:31]
    ds_read_b128 v[48:51], v5 offset:2048
    v_mfma_f32_16x16x32_bf16 v[32:35], v[92:95], v[144:147], v[32:35]
    ds_read_b128 v[52:55], v5 offset:3072
    v_mfma_f32_16x16x32_bf16 v[36:39], v[96:99], v[144:147], v[36:39]
    ds_read_b128 v[56:59], v5 offset:4096
    s_waitcnt vmcnt(18) lgkmcnt(5)
    v_mfma_f32_16x16x32_bf16 v[20:23], v[100:103], v[148:151], v[20:23]
    ds_read_b128 v[60:63], v5 offset:5120
    v_mfma_f32_16x16x32_bf16 v[24:27], v[104:107], v[148:151], v[24:27]
    ds_read_b128 v[64:67], v5 offset:6144
    v_mfma_f32_16x16x32_bf16 v[28:31], v[108:111], v[148:151], v[28:31]
    ds_read_b128 v[68:71], v5 offset:7168
    v_mfma_f32_16x16x32_bf16 v[32:35], v[112:115], v[148:151], v[32:35]
    ds_read_b128 v[72:75], v5 offset:8192
    v_mfma_f32_16x16x32_bf16 v[36:39], v[116:119], v[148:151], v[36:39]
    ds_read_b128 v[76:79], v5 offset:9216
    s_waitcnt vmcnt(17) lgkmcnt(5)
    v_mfma_f32_16x16x32_bf16 v[20:23], v[40:43], v[152:155], v[20:23]
    ds_read_b128 v[80:83], v5 offset:10240
    v_mfma_f32_16x16x32_bf16 v[24:27], v[44:47], v[152:155], v[24:27]
    ds_read_b128 v[84:87], v5 offset:11264
    v_mfma_f32_16x16x32_bf16 v[28:31], v[48:51], v[152:155], v[28:31]
    ds_read_b128 v[88:91], v5 offset:12288
    v_mfma_f32_16x16x32_bf16 v[32:35], v[52:55], v[152:155], v[32:35]
    ds_read_b128 v[92:95], v5 offset:13312
    v_mfma_f32_16x16x32_bf16 v[36:39], v[56:59], v[152:155], v[36:39]
    ds_read_b128 v[96:99], v5 offset:14336
    s_waitcnt vmcnt(15) lgkmcnt(5)
    v_mfma_f32_16x16x32_bf16 v[20:23], v[60:63], v[156:159], v[20:23]
    ds_read_b128 v[100:103], v5 offset:15360
    v_mfma_f32_16x16x32_bf16 v[24:27], v[64:67], v[156:159], v[24:27]
    ds_read_b128 v[104:107], v5 offset:16384
    v_mfma_f32_16x16x32_bf16 v[28:31], v[68:71], v[156:159], v[28:31]
    ds_read_b128 v[108:111], v5 offset:17408
    v_mfma_f32_16x16x32_bf16 v[32:35], v[72:75], v[156:159], v[32:35]
    ds_read_b128 v[112:115], v5 offset:18432
    v_mfma_f32_16x16x32_bf16 v[36:39], v[76:79], v[156:159], v[36:39]
    ds_read_b128 v[116:119], v5 offset:19456
    s_waitcnt vmcnt(12) lgkmcnt(5)
    s_barrier
    v_add_u32 v5, 0, v4
    v_mfma_f32_16x16x32_bf16 v[20:23], v[80:83], v[160:163], v[20:23]
    ds_read_b128 v[40:43], v5 offset:0
    v_mfma_f32_16x16x32_bf16 v[24:27], v[84:87], v[160:163], v[24:27]
    ds_read_b128 v[44:47], v5 offset:1024
    v_mfma_f32_16x16x32_bf16 v[28:31], v[88:91], v[160:163], v[28:31]
    ds_read_b128 v[48:51], v5 offset:2048
    v_mfma_f32_16x16x32_bf16 v[32:35], v[92:95], v[160:163], v[32:35]
    ds_read_b128 v[52:55], v5 offset:3072
    v_mfma_f32_16x16x32_bf16 v[36:39], v[96:99], v[160:163], v[36:39]
    ds_read_b128 v[56:59], v5 offset:4096
    s_waitcnt vmcnt(11) lgkmcnt(5)
    v_mfma_f32_16x16x32_bf16 v[20:23], v[100:103], v[164:167], v[20:23]
    ds_read_b128 v[60:63], v5 offset:5120
    v_mfma_f32_16x16x32_bf16 v[24:27], v[104:107], v[164:167], v[24:27]
    ds_read_b128 v[64:67], v5 offset:6144
    v_mfma_f32_16x16x32_bf16 v[28:31], v[108:111], v[164:167], v[28:31]
    ds_read_b128 v[68:71], v5 offset:7168
    v_mfma_f32_16x16x32_bf16 v[32:35], v[112:115], v[164:167], v[32:35]
    ds_read_b128 v[72:75], v5 offset:8192
    v_mfma_f32_16x16x32_bf16 v[36:39], v[116:119], v[164:167], v[36:39]
    ds_read_b128 v[76:79], v5 offset:9216
    s_waitcnt vmcnt(9) lgkmcnt(5)
    v_mfma_f32_16x16x32_bf16 v[20:23], v[40:43], v[120:123], v[20:23]
    ds_read_b128 v[80:83], v5 offset:10240
    v_mfma_f32_16x16x32_bf16 v[24:27], v[44:47], v[120:123], v[24:27]
    ds_read_b128 v[84:87], v5 offset:11264
    v_mfma_f32_16x16x32_bf16 v[28:31], v[48:51], v[120:123], v[28:31]
    ds_read_b128 v[88:91], v5 offset:12288
    v_mfma_f32_16x16x32_bf16 v[32:35], v[52:55], v[120:123], v[32:35]
    ds_read_b128 v[92:95], v5 offset:13312
    v_mfma_f32_16x16x32_bf16 v[36:39], v[56:59], v[120:123], v[36:39]
    ds_read_b128 v[96:99], v5 offset:14336
    s_waitcnt vmcnt(8) lgkmcnt(5)
    v_mfma_f32_16x16x32_bf16 v[20:23], v[60:63], v[124:127], v[20:23]
    ds_read_b128 v[100:103], v5 offset:15360
    v_mfma_f32_16x16x32_bf16 v[24:27], v[64:67], v[124:127], v[24:27]
    ds_read_b128 v[104:107], v5 offset:16384
    v_mfma_f32_16x16x32_bf16 v[28:31], v[68:71], v[124:127], v[28:31]
    ds_read_b128 v[108:111], v5 offset:17408
    v_mfma_f32_16x16x32_bf16 v[32:35], v[72:75], v[124:127], v[32:35]
    ds_read_b128 v[112:115], v5 offset:18432
    v_mfma_f32_16x16x32_bf16 v[36:39], v[76:79], v[124:127], v[36:39]
    ds_read_b128 v[116:119], v5 offset:19456
    s_waitcnt vmcnt(1) lgkmcnt(5)
    s_barrier
    v_add_u32 v5, 20480, v4
    v_mfma_f32_16x16x32_bf16 v[20:23], v[80:83], v[128:131], v[20:23]
    ds_read_b128 v[40:43], v5 offset:0
    v_mfma_f32_16x16x32_bf16 v[24:27], v[84:87], v[128:131], v[24:27]
    ds_read_b128 v[44:47], v5 offset:1024
    v_mfma_f32_16x16x32_bf16 v[28:31], v[88:91], v[128:131], v[28:31]
    ds_read_b128 v[48:51], v5 offset:2048
    v_mfma_f32_16x16x32_bf16 v[32:35], v[92:95], v[128:131], v[32:35]
    ds_read_b128 v[52:55], v5 offset:3072
    v_mfma_f32_16x16x32_bf16 v[36:39], v[96:99], v[128:131], v[36:39]
    ds_read_b128 v[56:59], v5 offset:4096
    s_waitcnt vmcnt(4) lgkmcnt(5)
    v_mfma_f32_16x16x32_bf16 v[20:23], v[100:103], v[132:135], v[20:23]
    ds_read_b128 v[60:63], v5 offset:5120
    v_mfma_f32_16x16x32_bf16 v[24:27], v[104:107], v[132:135], v[24:27]
    ds_read_b128 v[64:67], v5 offset:6144
    v_mfma_f32_16x16x32_bf16 v[28:31], v[108:111], v[132:135], v[28:31]
    ds_read_b128 v[68:71], v5 offset:7168
    v_mfma_f32_16x16x32_bf16 v[32:35], v[112:115], v[132:135], v[32:35]
    ds_read_b128 v[72:75], v5 offset:8192
    v_mfma_f32_16x16x32_bf16 v[36:39], v[116:119], v[132:135], v[36:39]
    ds_read_b128 v[76:79], v5 offset:9216
    s_waitcnt vmcnt(2) lgkmcnt(5)
    v_mfma_f32_16x16x32_bf16 v[20:23], v[40:43], v[136:139], v[20:23]
    v_mfma_f32_16x16x32_bf16 v[24:27], v[44:47], v[136:139], v[24:27]
    v_mfma_f32_16x16x32_bf16 v[28:31], v[48:51], v[136:139], v[28:31]
    v_mfma_f32_16x16x32_bf16 v[32:35], v[52:55], v[136:139], v[32:35]
    v_mfma_f32_16x16x32_bf16 v[36:39], v[56:59], v[136:139], v[36:39]
    s_waitcnt vmcnt(0) lgkmcnt(0)
    v_mfma_f32_16x16x32_bf16 v[20:23], v[60:63], v[140:143], v[20:23]
    v_mfma_f32_16x16x32_bf16 v[24:27], v[64:67], v[140:143], v[24:27]
    v_mfma_f32_16x16x32_bf16 v[28:31], v[68:71], v[140:143], v[28:31]
    v_mfma_f32_16x16x32_bf16 v[32:35], v[72:75], v[140:143], v[32:35]
    v_mfma_f32_16x16x32_bf16 v[36:39], v[76:79], v[140:143], v[36:39]
    v_mul_u32_u24 v2, 1280, v7
    v_lshrrev_b32 v4, 4, v1
    v_lshl_add_u32 v3, v4, 3, v2
    v_lshl_add_u32 v2, v8, 5, v2
    v_lshrrev_b32 v4, 5, v1
    v_lshl_add_u32 v2, v4, 4, v2
    s_mul_i32 s44, s55, 20480
    s_mul_i32 s45, s56, 160
    s_add_u32 s44, s44, s45
    v_cvt_pk_bf16_f32 v10, v20, v21
    v_cvt_pk_bf16_f32 v11, v22, v23
    v_cvt_pk_bf16_f32 v12, v24, v25
    v_cvt_pk_bf16_f32 v13, v26, v27
    v_cvt_pk_bf16_f32 v14, v28, v29
    v_cvt_pk_bf16_f32 v15, v30, v31
    v_cvt_pk_bf16_f32 v16, v32, v33
    v_cvt_pk_bf16_f32 v17, v34, v35
    v_cvt_pk_bf16_f32 v18, v36, v37
    v_cvt_pk_bf16_f32 v19, v38, v39
    buffer_store_dwordx2 v[18:19], v3, s[20:23], s44 offen offset:128 sc1
    v_permlane16_swap_b32 v10, v12
    v_permlane16_swap_b32 v11, v13
    v_permlane16_swap_b32 v14, v16
    v_permlane16_swap_b32 v15, v17
    buffer_store_dwordx4 v[10:13], v2, s[20:23], s44 offen offset:0 sc1
    buffer_store_dwordx4 v[14:17], v2, s[20:23], s44 offen offset:64 sc1
    s_endpgm
k2_stats:
    s_lshl_b32 s3, s3, 2
    s_add_u32 s3, s3, s14
    s_lshl_b32 s43, s3, 10
    s_mul_i32 s15, s81, 665600
    s_add_u32 s43, s43, s15
    v_lshlrev_b32 v2, 4, v1
    s_waitcnt lgkmcnt(0)
    s_add_u32 s24, s12, 0x520000
    s_addc_u32 s25, s13, 0
    s_mov_b32 s26, 0x28a000
    s_mov_b32 s27, 0x20000
    s_add_u32 s28, s12, 0x514000
    s_addc_u32 s29, s13, 0
    s_mov_b32 s30, 0x4000
    s_mov_b32 s31, 0x20000
    buffer_load_dwordx4 v[16:19], v2, s[24:27], s43 offen
    s_add_u32 s43, s43, 33280
    buffer_load_dwordx4 v[20:23], v2, s[24:27], s43 offen
    s_add_u32 s43, s43, 33280
    buffer_load_dwordx4 v[24:27], v2, s[24:27], s43 offen
    s_add_u32 s43, s43, 33280
    buffer_load_dwordx4 v[28:31], v2, s[24:27], s43 offen
    s_add_u32 s43, s43, 33280
    buffer_load_dwordx4 v[32:35], v2, s[24:27], s43 offen
    s_add_u32 s43, s43, 33280
    buffer_load_dwordx4 v[36:39], v2, s[24:27], s43 offen
    s_add_u32 s43, s43, 33280
    buffer_load_dwordx4 v[40:43], v2, s[24:27], s43 offen
    s_add_u32 s43, s43, 33280
    buffer_load_dwordx4 v[44:47], v2, s[24:27], s43 offen
    s_add_u32 s43, s43, 33280
    buffer_load_dwordx4 v[48:51], v2, s[24:27], s43 offen
    s_add_u32 s43, s43, 33280
    buffer_load_dwordx4 v[52:55], v2, s[24:27], s43 offen
    s_add_u32 s43, s43, 33280
    buffer_load_dwordx4 v[56:59], v2, s[24:27], s43 offen
    s_add_u32 s43, s43, 33280
    buffer_load_dwordx4 v[60:63], v2, s[24:27], s43 offen
    s_add_u32 s43, s43, 33280
    buffer_load_dwordx4 v[64:67], v2, s[24:27], s43 offen
    s_add_u32 s43, s43, 33280
    buffer_load_dwordx4 v[68:71], v2, s[24:27], s43 offen
    s_add_u32 s43, s43, 33280
    buffer_load_dwordx4 v[72:75], v2, s[24:27], s43 offen
    s_add_u32 s43, s43, 33280
    buffer_load_dwordx4 v[76:79], v2, s[24:27], s43 offen
    s_add_u32 s43, s43, 33280
    buffer_load_dwordx4 v[80:83], v2, s[24:27], s43 offen
    s_add_u32 s43, s43, 33280
    buffer_load_dwordx4 v[84:87], v2, s[24:27], s43 offen
    s_add_u32 s43, s43, 33280
    buffer_load_dwordx4 v[88:91], v2, s[24:27], s43 offen
    s_add_u32 s43, s43, 33280
    buffer_load_dwordx4 v[92:95], v2, s[24:27], s43 offen
    s_add_u32 s43, s43, 33280
    s_mov_b32 s36, 0x3f803f80
    v_mov_b32 v6, 0
    v_mov_b32 v7, 0
    v_lshlrev_b32 v3, 3, v0
    s_waitcnt vmcnt(19)
    v_dot2c_f32_bf16 v6, s36, v16
    v_dot2c_f32_bf16 v7, v16, v16
    v_dot2c_f32_bf16 v6, s36, v17
    v_dot2c_f32_bf16 v7, v17, v17
    v_dot2c_f32_bf16 v6, s36, v18
    v_dot2c_f32_bf16 v7, v18, v18
    v_dot2c_f32_bf16 v6, s36, v19
    v_dot2c_f32_bf16 v7, v19, v19
    s_waitcnt vmcnt(18)
    v_dot2c_f32_bf16 v6, s36, v20
    v_dot2c_f32_bf16 v7, v20, v20
    v_dot2c_f32_bf16 v6, s36, v21
    v_dot2c_f32_bf16 v7, v21, v21
    v_dot2c_f32_bf16 v6, s36, v22
    v_dot2c_f32_bf16 v7, v22, v22
    v_dot2c_f32_bf16 v6, s36, v23
    v_dot2c_f32_bf16 v7, v23, v23
    s_waitcnt vmcnt(17)
    v_dot2c_f32_bf16 v6, s36, v24
    v_dot2c_f32_bf16 v7, v24, v24
    v_dot2c_f32_bf16 v6, s36, v25
    v_dot2c_f32_bf16 v7, v25, v25
    v_dot2c_f32_bf16 v6, s36, v26
    v_dot2c_f32_bf16 v7, v26, v26
    v_dot2c_f32_bf16 v6, s36, v27
    v_dot2c_f32_bf16 v7, v27, v27
    s_waitcnt vmcnt(16)
    v_dot2c_f32_bf16 v6, s36, v28
    v_dot2c_f32_bf16 v7, v28, v28
    v_dot2c_f32_bf16 v6, s36, v29
    v_dot2c_f32_bf16 v7, v29, v29
    v_dot2c_f32_bf16 v6, s36, v30
    v_dot2c_f32_bf16 v7, v30, v30
    v_dot2c_f32_bf16 v6, s36, v31
    v_dot2c_f32_bf16 v7, v31, v31
    s_waitcnt vmcnt(15)
    v_dot2c_f32_bf16 v6, s36, v32
    v_dot2c_f32_bf16 v7, v32, v32
    v_dot2c_f32_bf16 v6, s36, v33
    v_dot2c_f32_bf16 v7, v33, v33
    v_dot2c_f32_bf16 v6, s36, v34
    v_dot2c_f32_bf16 v7, v34, v34
    v_dot2c_f32_bf16 v6, s36, v35
    v_dot2c_f32_bf16 v7, v35, v35
    s_waitcnt vmcnt(14)
    v_dot2c_f32_bf16 v6, s36, v36
    v_dot2c_f32_bf16 v7, v36, v36
    v_dot2c_f32_bf16 v6, s36, v37
    v_dot2c_f32_bf16 v7, v37, v37
    v_dot2c_f32_bf16 v6, s36, v38
    v_dot2c_f32_bf16 v7, v38, v38
    v_dot2c_f32_bf16 v6, s36, v39
    v_dot2c_f32_bf16 v7, v39, v39
    s_waitcnt vmcnt(13)
    v_dot2c_f32_bf16 v6, s36, v40
    v_dot2c_f32_bf16 v7, v40, v40
    v_dot2c_f32_bf16 v6, s36, v41
    v_dot2c_f32_bf16 v7, v41, v41
    v_dot2c_f32_bf16 v6, s36, v42
    v_dot2c_f32_bf16 v7, v42, v42
    v_dot2c_f32_bf16 v6, s36, v43
    v_dot2c_f32_bf16 v7, v43, v43
    s_waitcnt vmcnt(12)
    v_dot2c_f32_bf16 v6, s36, v44
    v_dot2c_f32_bf16 v7, v44, v44
    v_dot2c_f32_bf16 v6, s36, v45
    v_dot2c_f32_bf16 v7, v45, v45
    v_dot2c_f32_bf16 v6, s36, v46
    v_dot2c_f32_bf16 v7, v46, v46
    v_dot2c_f32_bf16 v6, s36, v47
    v_dot2c_f32_bf16 v7, v47, v47
    s_waitcnt vmcnt(11)
    v_dot2c_f32_bf16 v6, s36, v48
    v_dot2c_f32_bf16 v7, v48, v48
    v_dot2c_f32_bf16 v6, s36, v49
    v_dot2c_f32_bf16 v7, v49, v49
    v_dot2c_f32_bf16 v6, s36, v50
    v_dot2c_f32_bf16 v7, v50, v50
    v_dot2c_f32_bf16 v6, s36, v51
    v_dot2c_f32_bf16 v7, v51, v51
    s_waitcnt vmcnt(10)
    v_dot2c_f32_bf16 v6, s36, v52
    v_dot2c_f32_bf16 v7, v52, v52
    v_dot2c_f32_bf16 v6, s36, v53
    v_dot2c_f32_bf16 v7, v53, v53
    v_dot2c_f32_bf16 v6, s36, v54
    v_dot2c_f32_bf16 v7, v54, v54
    v_dot2c_f32_bf16 v6, s36, v55
    v_dot2c_f32_bf16 v7, v55, v55
    s_waitcnt vmcnt(9)
    v_dot2c_f32_bf16 v6, s36, v56
    v_dot2c_f32_bf16 v7, v56, v56
    v_dot2c_f32_bf16 v6, s36, v57
    v_dot2c_f32_bf16 v7, v57, v57
    v_dot2c_f32_bf16 v6, s36, v58
    v_dot2c_f32_bf16 v7, v58, v58
    v_dot2c_f32_bf16 v6, s36, v59
    v_dot2c_f32_bf16 v7, v59, v59
    s_waitcnt vmcnt(8)
    v_dot2c_f32_bf16 v6, s36, v60
    v_dot2c_f32_bf16 v7, v60, v60
    v_dot2c_f32_bf16 v6, s36, v61
    v_dot2c_f32_bf16 v7, v61, v61
    v_dot2c_f32_bf16 v6, s36, v62
    v_dot2c_f32_bf16 v7, v62, v62
    v_dot2c_f32_bf16 v6, s36, v63
    v_dot2c_f32_bf16 v7, v63, v63
    s_waitcnt vmcnt(7)
    v_dot2c_f32_bf16 v6, s36, v64
    v_dot2c_f32_bf16 v7, v64, v64
    v_dot2c_f32_bf16 v6, s36, v65
    v_dot2c_f32_bf16 v7, v65, v65
    v_dot2c_f32_bf16 v6, s36, v66
    v_dot2c_f32_bf16 v7, v66, v66
    v_dot2c_f32_bf16 v6, s36, v67
    v_dot2c_f32_bf16 v7, v67, v67
    s_waitcnt vmcnt(6)
    v_dot2c_f32_bf16 v6, s36, v68
    v_dot2c_f32_bf16 v7, v68, v68
    v_dot2c_f32_bf16 v6, s36, v69
    v_dot2c_f32_bf16 v7, v69, v69
    v_dot2c_f32_bf16 v6, s36, v70
    v_dot2c_f32_bf16 v7, v70, v70
    v_dot2c_f32_bf16 v6, s36, v71
    v_dot2c_f32_bf16 v7, v71, v71
    s_waitcnt vmcnt(5)
    v_dot2c_f32_bf16 v6, s36, v72
    v_dot2c_f32_bf16 v7, v72, v72
    v_dot2c_f32_bf16 v6, s36, v73
    v_dot2c_f32_bf16 v7, v73, v73
    v_dot2c_f32_bf16 v6, s36, v74
    v_dot2c_f32_bf16 v7, v74, v74
    v_dot2c_f32_bf16 v6, s36, v75
    v_dot2c_f32_bf16 v7, v75, v75
    s_waitcnt vmcnt(4)
    v_dot2c_f32_bf16 v6, s36, v76
    v_dot2c_f32_bf16 v7, v76, v76
    v_dot2c_f32_bf16 v6, s36, v77
    v_dot2c_f32_bf16 v7, v77, v77
    v_dot2c_f32_bf16 v6, s36, v78
    v_dot2c_f32_bf16 v7, v78, v78
    v_dot2c_f32_bf16 v6, s36, v79
    v_dot2c_f32_bf16 v7, v79, v79
    s_waitcnt vmcnt(3)
    v_dot2c_f32_bf16 v6, s36, v80
    v_dot2c_f32_bf16 v7, v80, v80
    v_dot2c_f32_bf16 v6, s36, v81
    v_dot2c_f32_bf16 v7, v81, v81
    v_dot2c_f32_bf16 v6, s36, v82
    v_dot2c_f32_bf16 v7, v82, v82
    v_dot2c_f32_bf16 v6, s36, v83
    v_dot2c_f32_bf16 v7, v83, v83
    s_waitcnt vmcnt(2)
    v_dot2c_f32_bf16 v6, s36, v84
    v_dot2c_f32_bf16 v7, v84, v84
    v_dot2c_f32_bf16 v6, s36, v85
    v_dot2c_f32_bf16 v7, v85, v85
    v_dot2c_f32_bf16 v6, s36, v86
    v_dot2c_f32_bf16 v7, v86, v86
    v_dot2c_f32_bf16 v6, s36, v87
    v_dot2c_f32_bf16 v7, v87, v87
    s_waitcnt vmcnt(1)
    v_dot2c_f32_bf16 v6, s36, v88
    v_dot2c_f32_bf16 v7, v88, v88
    v_dot2c_f32_bf16 v6, s36, v89
    v_dot2c_f32_bf16 v7, v89, v89
    v_dot2c_f32_bf16 v6, s36, v90
    v_dot2c_f32_bf16 v7, v90, v90
    v_dot2c_f32_bf16 v6, s36, v91
    v_dot2c_f32_bf16 v7, v91, v91
    s_waitcnt vmcnt(0)
    v_dot2c_f32_bf16 v6, s36, v92
    v_dot2c_f32_bf16 v7, v92, v92
    v_dot2c_f32_bf16 v6, s36, v93
    v_dot2c_f32_bf16 v7, v93, v93
    v_dot2c_f32_bf16 v6, s36, v94
    v_dot2c_f32_bf16 v7, v94, v94
    v_dot2c_f32_bf16 v6, s36, v95
    v_dot2c_f32_bf16 v7, v95, v95
    s_nop 2
    ds_write_b64 v3, v[6:7]
    s_waitcnt lgkmcnt(0)
    s_barrier
    s_cmp_lg_u32 s81, 0
    s_cbranch_scc1 k2_idle
    ds_read_b64 v[8:9], v3 offset:512
    ds_read2st64_b64 v[10:13], v3 offset0:2 offset1:3
    s_lshl_b32 s46, s3, 9
    s_waitcnt lgkmcnt(0)
    v_pk_add_f32 v[6:7], v[6:7], v[8:9]
    v_pk_add_f32 v[10:11], v[10:11], v[12:13]
    v_pk_add_f32 v[6:7], v[6:7], v[10:11]
    v_mul_f32 v6, -0.0015625, v6
    v_mul_f32 v7, 0.0015625, v7
    v_fma_f32 v7, -v6, v6, v7
    v_max_f32 v7, 0, v7
    v_add_f32 v7, 0x3727c5ac, v7
    v_rsq_f32 v8, v7
    v_cvt_pk_bf16_f32 v9, v6, v6
    v_lshlrev_b32 v10, 16, v9
    v_sub_f32 v6, v6, v10
    v_cvt_pk_bf16_f32 v9, v10, v6
    v_min_u32 v8, -2, v8
    v_min_u32 v9, -2, v9
    buffer_store_dwordx2 v[8:9], v3, s[28:31], s46 offen sc0 sc1
k2_idle:
    v_lshlrev_b32 v2, 4, v1
    s_mov_b32 s59, -1
    s_waitcnt lgkmcnt(0)
    s_add_u32 s60, s12, 0x1300000
    s_addc_u32 s61, s13, 0
    s_mov_b32 s62, 0x80000
    s_mov_b32 s63, 0x20000
    s_load_dword s65, s[60:61], 0x7ff00
    s_load_dwordx2 s[8:9], s[0:1], 80
    s_and_b32 s58, s2, 1
    s_lshl_b32 s56, s58, 2
    s_bfe_u32 s15, s2, 0x20003
    s_add_u32 s56, s56, s15
    s_and_b32 s55, s2, 6
    s_lshl_b32 s55, s55, 4
    s_lshr_b32 s15, s2, 3
    s_and_b32 s57, s15, 28
    s_add_u32 s55, s55, s57
    s_lshr_b32 s57, s55, 4
    s_lshl_b32 s57, s57, 1
    s_add_u32 s57, s57, s58
    s_lshl_b32 s57, s57, 4
    s_and_b32 s15, s15, 15
    s_add_u32 s57, s57, s15
    s_lshl_b32 s57, s57, 8
    s_add_u32 s57, s57, 262144
    s_add_u32 s55, s55, s81
    s_mul_i32 s15, s56, 276480
    s_add_u32 s15, s15, 16777216
    s_add_u32 s48, s12, s15
    s_addc_u32 s49, s13, 0
    s_mul_i32 s53, s81, 5120
    s_mov_b32 s50, 0x43800
    s_mov_b32 s51, 0x20000
    s_add_u32 m0, s53, 86016
    s_add_u32 s54, s53, 4096
    buffer_load_dwordx4 v2, s[48:51], s54 offen lds
    s_add_u32 m0, s53, 81920
    s_add_u32 s54, s53, 0
    buffer_load_dwordx4 v2, s[48:51], s54 offen lds
    buffer_load_dwordx4 v2, s[48:51], s54 offen offset:1024 lds
    buffer_load_dwordx4 v2, s[48:51], s54 offen offset:2048 lds
    buffer_load_dwordx4 v2, s[48:51], s54 offen offset:3072 lds
    s_add_u32 m0, s53, 106496
    s_add_u32 s54, s53, 24576
    buffer_load_dwordx4 v2, s[48:51], s54 offen lds
    s_add_u32 m0, s53, 102400
    s_add_u32 s54, s53, 20480
    buffer_load_dwordx4 v2, s[48:51], s54 offen lds
    buffer_load_dwordx4 v2, s[48:51], s54 offen offset:1024 lds
    buffer_load_dwordx4 v2, s[48:51], s54 offen offset:2048 lds
    buffer_load_dwordx4 v2, s[48:51], s54 offen offset:3072 lds
    s_add_u32 m0, s53, 126976
    s_add_u32 s54, s53, 45056
    buffer_load_dwordx4 v2, s[48:51], s54 offen lds
    s_add_u32 m0, s53, 122880
    s_add_u32 s54, s53, 40960
    buffer_load_dwordx4 v2, s[48:51], s54 offen lds
    buffer_load_dwordx4 v2, s[48:51], s54 offen offset:1024 lds
    buffer_load_dwordx4 v2, s[48:51], s54 offen offset:2048 lds
    buffer_load_dwordx4 v2, s[48:51], s54 offen offset:3072 lds
    s_add_u32 m0, s53, 147456
    s_add_u32 s54, s53, 65536
    buffer_load_dwordx4 v2, s[48:51], s54 offen lds
    s_add_u32 m0, s53, 143360
    s_add_u32 s54, s53, 61440
    buffer_load_dwordx4 v2, s[48:51], s54 offen lds
    buffer_load_dwordx4 v2, s[48:51], s54 offen offset:1024 lds
    buffer_load_dwordx4 v2, s[48:51], s54 offen offset:2048 lds
    buffer_load_dwordx4 v2, s[48:51], s54 offen offset:3072 lds
    s_branch k3_join
k2_end:
    s_endpgm
code_end:
.section .rodata,"a"
.p2align 6
.amdhsa_kernel front_kernel
  .amdhsa_next_free_vgpr 176
  .amdhsa_next_free_sgpr 102
  .amdhsa_accum_offset 176
  .amdhsa_group_segment_fixed_size 0
  .amdhsa_kernarg_size 104
  .amdhsa_user_sgpr_count 2
  .amdhsa_user_sgpr_kernarg_segment_ptr 1
  .amdhsa_system_sgpr_workgroup_id_x 1
.end_amdhsa_kernel
.p2align 6
.amdhsa_kernel back_kernel
  .amdhsa_next_free_vgpr 280
  .amdhsa_next_free_sgpr 102
  .amdhsa_accum_offset 256
  .amdhsa_group_segment_fixed_size 0
  .amdhsa_kernarg_size 104
  .amdhsa_user_sgpr_count 2
  .amdhsa_user_sgpr_kernarg_segment_ptr 1
  .amdhsa_system_sgpr_workgroup_id_x 1
.end_amdhsa_kernel
```
